```python
import torch

def _softmax(x, axis=-1):
    return torch.softmax(x, dim=axis)
def _gelu(x):
    return torch.nn.functional.gelu(x, approximate="tanh")
def _silu(x):
    return torch.nn.functional.silu(x)
def _sigmoid(x):
    return torch.sigmoid(x)
def _layernorm(x, axis=-1, eps=1e-5):
    m = x.mean(dim=axis, keepdim=True)
    v = x.var(dim=axis, keepdim=True, unbiased=False)
    return (x - m) / torch.sqrt(v + eps)
def _scatter_add(tgt, idx, src, axis=0):
    return tgt.clone().index_add_(axis, idx, src)
def _segment_sum(src, seg, n):
    out = torch.zeros((n,) + src.shape[1:], dtype=src.dtype)
    return out.index_add_(0, seg, src)
def _pad(x, pw):
    flat = tuple(v for pair in reversed(pw) for v in pair)
    return torch.nn.functional.pad(x, flat)

kernel_name = 'sequential_preLN__gqa_block_cached__mixer_token_mlp__decode'

def setup_inputs():

    _w = (lambda a: (lambda t: t.to(torch.bfloat16) if t.is_floating_point() else t)(torch.as_tensor(a)))
    def _A_setup():
        B, Sq, D = 1, 1, 512
        Hq, Hkv, Sk, Dh = 32, 8, 65536, 128
        assert Hq % Hkv == 0, (Hq, Hkv)
        return {
            "x": _w((lambda *s: torch.randn(*s, dtype=torch.bfloat16) * 0.1)(B, Sq, D)),
            "k_cache": _w((lambda *s: torch.randn(*s, dtype=torch.bfloat16) * 1.6)(B, Hkv, Sk, Dh)),
            "v_cache": _w((lambda *s: torch.randn(*s, dtype=torch.bfloat16) * 1.6)(B, Hkv, Sk, Dh)),
            "wq": _w((lambda *s: torch.randn(*s, dtype=torch.bfloat16) * 1.6)(D, Hq * Dh) * (D ** -0.5)),
            "wo": _w((lambda *s: torch.randn(*s, dtype=torch.bfloat16) * 1.6)(Hq * Dh, D) * ((Hq * Dh) ** -0.5)),
        }
    _A_in = _A_setup()

    def _B_setup():
        B, S, D, F = 1, 1, 512, 1792
        return {
            "x": _w((lambda *s: torch.randn(*s, dtype=torch.bfloat16) * 0.1)(B, S, D)),
            "w1": _w((lambda *s: torch.randn(*s, dtype=torch.bfloat16) * 1.6)(S, F) * (S ** -0.5)),
            "b1": _w((lambda *s: torch.randn(*s, dtype=torch.bfloat16) * 1.6)(F) * 0.02),
            "w2": _w((lambda *s: torch.randn(*s, dtype=torch.bfloat16) * 1.6)(F, S) * (F ** -0.5)),
            "b2": _w((lambda *s: torch.randn(*s, dtype=torch.bfloat16) * 1.6)(S) * 0.02),
        }
    _B_in = _B_setup()

    return {
        "A_x": _A_in["x"],
        "A_k_cache": _A_in["k_cache"],
        "A_v_cache": _A_in["v_cache"],
        "A_wq": _A_in["wq"],
        "A_wo": _A_in["wo"],
        "B_x": _B_in["x"],
        "B_w1": _B_in["w1"],
        "B_b1": _B_in["b1"],
        "B_w2": _B_in["w2"],
        "B_b2": _B_in["b2"],
    }

def reference(A_x, A_k_cache, A_v_cache, A_wq, A_wo, B_x, B_w1, B_b1, B_w2, B_b2):
    def _A_ref(x, k_cache, v_cache, wq, wo):
        B, Sq, D = x.shape
        Hq, Dh = 32, 128
        Hkv = k_cache.shape[1]
        rep = Hq // Hkv
        q = (lambda x, *d: x.permute(*d))((x @ wq).reshape(B, Sq, Hq, Dh), 0, 2, 1, 3)
        k = (lambda x, n, axis: torch.repeat_interleave(x, n, dim=axis))(k_cache, rep, axis=1)
        v = (lambda x, n, axis: torch.repeat_interleave(x, n, dim=axis))(v_cache, rep, axis=1)
        scores = torch.einsum("bhqd,bhkd->bhqk", q, k) * (Dh ** -0.5)
        p = _softmax(scores, axis=-1)
        o = torch.einsum("bhqk,bhkd->bhqd", p, v)
        return (lambda x, *d: x.permute(*d))(o, 0, 2, 1, 3).reshape(B, Sq, Hq * Dh) @ wo

    def _B_ref(x, w1, b1, w2, b2):
        B, S, D = x.shape
        h = _layernorm(x, axis=-1)
        u = torch.einsum("bsd,sf->bdf", h, w1) + b1
        u = _gelu(u)
        y = torch.einsum("bdf,fs->bds", u, w2) + b2
        return (lambda x, *d: x.permute(*d))(y, 0, 2, 1)

    x = A_x
    h = x + _A_ref(_layernorm(x, axis=-1), A_k_cache, A_v_cache, A_wq, A_wo)
    h2 = h + _B_ref(_layernorm(h, axis=-1), B_w1, B_b1, B_w2, B_b2)
    return h2
```

```asm
; @launch grid=(256,1,1) block=(512,1,1) lds=16720
.amdgcn_target "amdgcn-amd-amdhsa--gfx950"
.text
.globl sequential_preLN__gqa_block_cached__mixer_token_mlp__decode_kernel
.p2align 8
.type sequential_preLN__gqa_block_cached__mixer_token_mlp__decode_kernel,@function
sequential_preLN__gqa_block_cached__mixer_token_mlp__decode_kernel:
s_cmp_ge_u32 s2, 256
s_cbranch_scc1 L_end
s_load_dwordx16 s[4:19], s[0:1], 0
s_load_dwordx8 s[20:27], s[0:1], 64
s_load_dwordx2 s[28:29], s[0:1], 96
v_lshrrev_b32 v1, 6, v0
v_and_b32 v0, 63, v0
v_readfirstlane_b32 s30, v1
s_and_b32 s31, s2, 7
s_lshr_b32 s32, s2, 3
s_lshl_b32 s3, s31, 5
s_add_u32 s3, s3, s32
s_sub_u32 s33, s30, 4
s_lshr_b32 s34, s32, 3
s_and_b32 s35, s32, 7
s_cmp_lt_u32 s33, 2
s_cbranch_scc1 L_hq
s_cmp_ge_u32 s30, 4
s_cbranch_scc1 L_cover
v_and_b32 v4, 3, v0
v_lshlrev_b32 v4, 10, v4
v_bfe_u32 v5, v0, 2, 2
v_lshlrev_b32 v5, 8, v5
v_lshrrev_b32 v6, 4, v0
v_lshlrev_b32 v6, 4, v6
v_add3_u32 v1, v4, v5, v6
v_lshlrev_b32 v2, 4, v0
s_lshl_b32 s44, s31, 24
s_lshl_b32 s45, s32, 19
s_add_u32 s44, s44, s45
s_mov_b32 s46, s30
s_lshl_b32 s45, s46, 12
s_add_u32 s44, s44, s45
s_waitcnt lgkmcnt(0)
s_mov_b32 s36, s6
s_and_b32 s37, s7, 0xffff
s_mov_b32 s38, 0x8000000
s_mov_b32 s39, 0x20000
s_mov_b32 s40, s8
s_and_b32 s41, s9, 0xffff
s_mov_b32 s42, 0x8000000
s_mov_b32 s43, 0x20000
s_add_u32 s45, s44, 0x0
buffer_load_dwordx4 v[64:67], v1, s[36:39], s45 offen offset:0 nt
buffer_load_dwordx4 v[68:71], v1, s[36:39], s45 offen offset:64 nt
buffer_load_dwordx4 v[72:75], v1, s[36:39], s45 offen offset:128 nt
buffer_load_dwordx4 v[76:79], v1, s[36:39], s45 offen offset:192 nt
s_add_u32 s45, s44, 0x6000
buffer_load_dwordx4 v[80:83], v1, s[36:39], s45 offen offset:0 nt
buffer_load_dwordx4 v[84:87], v1, s[36:39], s45 offen offset:64 nt
buffer_load_dwordx4 v[88:91], v1, s[36:39], s45 offen offset:128 nt
buffer_load_dwordx4 v[92:95], v1, s[36:39], s45 offen offset:192 nt
s_barrier
s_mov_b32 s48, 0x11111111
s_mov_b32 s49, 0x11111111
s_mov_b32 s50, 0x22222222
s_mov_b32 s51, 0x22222222
s_mov_b32 s52, 0x44444444
s_mov_b32 s53, 0x44444444
s_mov_b32 s54, 0x88888888
s_mov_b32 s55, 0x88888888
s_mov_b32 s56, 0x3db504f3
s_mov_b32 s57, 0x3fb8aa3b
v_and_b32 v4, 1, v0
v_lshlrev_b32 v4, 4, v4
v_mov_b32 v5, 0xffff
v_lshlrev_b32 v5, v4, v5
v_and_b32 v4, 2, v0
v_cmp_eq_u32 vcc, 0, v4
v_mov_b32 v6, 0
s_nop 0
v_cndmask_b32 v60, v6, v5, vcc
v_cndmask_b32 v61, v5, v6, vcc
v_mov_b32 v46, 0xff800000
v_mov_b32 v47, 0
v_mov_b32 v48, 0
v_mov_b32 v49, 0
v_mov_b32 v50, 0
v_mov_b32 v51, 0
v_mov_b32 v52, 0
v_mov_b32 v53, 0
v_mov_b32 v54, 0
v_mov_b32 v55, 0
v_bfe_u32 v62, v0, 2, 2
v_lshlrev_b32 v62, 8, v62
v_lshrrev_b32 v63, 4, v0
v_lshl_add_u32 v62, v63, 4, v62
s_waitcnt vmcnt(4)
s_add_u32 s45, s44, 0xc000
buffer_load_dwordx4 v[96:99], v1, s[36:39], s45 offen offset:0 nt
buffer_load_dwordx4 v[100:103], v1, s[36:39], s45 offen offset:64 nt
buffer_load_dwordx4 v[104:107], v1, s[36:39], s45 offen offset:128 nt
buffer_load_dwordx4 v[108:111], v1, s[36:39], s45 offen offset:192 nt
s_waitcnt vmcnt(4)
s_add_u32 s45, s44, 0x12000
buffer_load_dwordx4 v[112:115], v1, s[36:39], s45 offen offset:0 nt
buffer_load_dwordx4 v[116:119], v1, s[36:39], s45 offen offset:64 nt
buffer_load_dwordx4 v[120:123], v1, s[36:39], s45 offen offset:128 nt
buffer_load_dwordx4 v[124:127], v1, s[36:39], s45 offen offset:192 nt
s_waitcnt vmcnt(4)
s_add_u32 s45, s44, 0x18000
buffer_load_dwordx4 v[128:131], v1, s[36:39], s45 offen offset:0 nt
buffer_load_dwordx4 v[132:135], v1, s[36:39], s45 offen offset:64 nt
buffer_load_dwordx4 v[136:139], v1, s[36:39], s45 offen offset:128 nt
buffer_load_dwordx4 v[140:143], v1, s[36:39], s45 offen offset:192 nt
s_waitcnt vmcnt(4)
s_add_u32 s45, s44, 0x0
buffer_load_dwordx4 v[144:147], v2, s[40:43], s45 offen offset:0 nt
buffer_load_dwordx4 v[148:151], v2, s[40:43], s45 offen offset:1024 nt
buffer_load_dwordx4 v[152:155], v2, s[40:43], s45 offen offset:2048 nt
buffer_load_dwordx4 v[156:159], v2, s[40:43], s45 offen offset:3072 nt
s_waitcnt vmcnt(4)
s_add_u32 s45, s44, 0x1e000
buffer_load_dwordx4 v[160:163], v1, s[36:39], s45 offen offset:0 nt
buffer_load_dwordx4 v[164:167], v1, s[36:39], s45 offen offset:64 nt
buffer_load_dwordx4 v[168:171], v1, s[36:39], s45 offen offset:128 nt
buffer_load_dwordx4 v[172:175], v1, s[36:39], s45 offen offset:192 nt
s_waitcnt vmcnt(4)
s_add_u32 s45, s44, 0x6000
buffer_load_dwordx4 v[176:179], v2, s[40:43], s45 offen offset:0 nt
buffer_load_dwordx4 v[180:183], v2, s[40:43], s45 offen offset:1024 nt
buffer_load_dwordx4 v[184:187], v2, s[40:43], s45 offen offset:2048 nt
buffer_load_dwordx4 v[188:191], v2, s[40:43], s45 offen offset:3072 nt
s_waitcnt vmcnt(4)
s_add_u32 s45, s44, 0x24000
buffer_load_dwordx4 v[192:195], v1, s[36:39], s45 offen offset:0 nt
buffer_load_dwordx4 v[196:199], v1, s[36:39], s45 offen offset:64 nt
buffer_load_dwordx4 v[200:203], v1, s[36:39], s45 offen offset:128 nt
buffer_load_dwordx4 v[204:207], v1, s[36:39], s45 offen offset:192 nt
s_waitcnt vmcnt(4)
s_add_u32 s45, s44, 0xc000
buffer_load_dwordx4 v[208:211], v2, s[40:43], s45 offen offset:0 nt
buffer_load_dwordx4 v[212:215], v2, s[40:43], s45 offen offset:1024 nt
buffer_load_dwordx4 v[216:219], v2, s[40:43], s45 offen offset:2048 nt
buffer_load_dwordx4 v[220:223], v2, s[40:43], s45 offen offset:3072 nt
s_waitcnt vmcnt(4)
s_add_u32 s45, s44, 0x2a000
buffer_load_dwordx4 v[224:227], v1, s[36:39], s45 offen offset:0 nt
buffer_load_dwordx4 v[228:231], v1, s[36:39], s45 offen offset:64 nt
buffer_load_dwordx4 v[232:235], v1, s[36:39], s45 offen offset:128 nt
buffer_load_dwordx4 v[236:239], v1, s[36:39], s45 offen offset:192 nt
s_waitcnt vmcnt(4)
s_add_u32 s45, s44, 0x12000
buffer_load_dwordx4 v[240:243], v2, s[40:43], s45 offen offset:0 nt
buffer_load_dwordx4 v[244:247], v2, s[40:43], s45 offen offset:1024 nt
buffer_load_dwordx4 v[248:251], v2, s[40:43], s45 offen offset:2048 nt
buffer_load_dwordx4 v[252:255], v2, s[40:43], s45 offen offset:3072 nt
s_barrier
ds_read_b128 v[4:7], v62 offset:0
ds_read_b128 v[8:11], v62 offset:64
ds_read_b128 v[12:15], v62 offset:128
ds_read_b128 v[16:19], v62 offset:192
s_waitcnt lgkmcnt(0)
s_waitcnt vmcnt(44)
v_mfma_f32_16x16x32_bf16 v[20:23], v[64:67], v[4:7], 0
v_mfma_f32_16x16x32_bf16 v[20:23], v[68:71], v[8:11], v[20:23]
v_mfma_f32_16x16x32_bf16 v[20:23], v[72:75], v[12:15], v[20:23]
v_mfma_f32_16x16x32_bf16 v[20:23], v[76:79], v[16:19], v[20:23]
s_add_u32 s45, s44, 0x30000
buffer_load_dwordx4 v[64:67], v1, s[36:39], s45 offen offset:0 nt
buffer_load_dwordx4 v[68:71], v1, s[36:39], s45 offen offset:64 nt
buffer_load_dwordx4 v[72:75], v1, s[36:39], s45 offen offset:128 nt
buffer_load_dwordx4 v[76:79], v1, s[36:39], s45 offen offset:192 nt
s_waitcnt vmcnt(44)
v_mfma_f32_16x16x32_bf16 v[24:27], v[80:83], v[4:7], 0
v_mfma_f32_16x16x32_bf16 v[24:27], v[84:87], v[8:11], v[24:27]
v_mfma_f32_16x16x32_bf16 v[24:27], v[88:91], v[12:15], v[24:27]
v_mfma_f32_16x16x32_bf16 v[24:27], v[92:95], v[16:19], v[24:27]
s_nop 4
v_cvt_pk_bf16_f32 v28, v20, v21
v_cvt_pk_bf16_f32 v29, v22, v23
s_waitcnt vmcnt(40)
v_mfma_f32_16x16x32_bf16 v[20:23], v[96:99], v[4:7], 0
v_mfma_f32_16x16x32_bf16 v[20:23], v[100:103], v[8:11], v[20:23]
v_mfma_f32_16x16x32_bf16 v[20:23], v[104:107], v[12:15], v[20:23]
v_mfma_f32_16x16x32_bf16 v[20:23], v[108:111], v[16:19], v[20:23]
s_add_u32 s45, s44, 0x18000
buffer_load_dwordx4 v[80:83], v2, s[40:43], s45 offen offset:0 nt
buffer_load_dwordx4 v[84:87], v2, s[40:43], s45 offen offset:1024 nt
buffer_load_dwordx4 v[88:91], v2, s[40:43], s45 offen offset:2048 nt
buffer_load_dwordx4 v[92:95], v2, s[40:43], s45 offen offset:3072 nt
v_cvt_pk_bf16_f32 v62, v24, v25
v_cvt_pk_bf16_f32 v63, v26, v27
v_cndmask_b32 v28, v28, v62, s[50:51]
v_cndmask_b32 v29, v29, v63, s[50:51]
s_waitcnt vmcnt(40)
v_mfma_f32_16x16x32_bf16 v[24:27], v[112:115], v[4:7], 0
v_mfma_f32_16x16x32_bf16 v[24:27], v[116:119], v[8:11], v[24:27]
v_mfma_f32_16x16x32_bf16 v[24:27], v[120:123], v[12:15], v[24:27]
v_mfma_f32_16x16x32_bf16 v[24:27], v[124:127], v[16:19], v[24:27]
s_nop 4
v_cvt_pk_bf16_f32 v62, v20, v21
v_cvt_pk_bf16_f32 v63, v22, v23
v_cndmask_b32 v28, v28, v62, s[52:53]
v_cndmask_b32 v29, v29, v63, s[52:53]
s_nop 3
v_cvt_pk_bf16_f32 v62, v24, v25
v_cvt_pk_bf16_f32 v63, v26, v27
v_cndmask_b32 v28, v28, v62, s[54:55]
v_cndmask_b32 v29, v29, v63, s[54:55]
v_lshlrev_b32 v38, 16, v28
v_and_b32 v39, 0xffff0000, v28
v_lshlrev_b32 v40, 16, v29
v_and_b32 v41, 0xffff0000, v29
v_mul_f32 v38, s56, v38
v_mul_f32 v39, s56, v39
v_mul_f32 v40, s56, v40
v_mul_f32 v41, s56, v41
v_cvt_pk_bf16_f32 v42, v38, v39
v_lshlrev_b32 v38, 16, v42
v_and_b32 v39, 0xffff0000, v42
v_cvt_pk_bf16_f32 v43, v40, v41
v_lshlrev_b32 v40, 16, v43
v_and_b32 v41, 0xffff0000, v43
v_max3_f32 v42, v38, v39, v40
v_max_f32 v42, v42, v41
v_cmp_gt_f32 vcc, v42, v46
s_cbranch_vccz L_grp_1
s_nop 1
v_max_f32_dpp v42, v42, v42 quad_perm:[1,0,3,2] row_mask:0xf bank_mask:0xf
s_nop 1
v_max_f32_dpp v42, v42, v42 quad_perm:[2,3,0,1] row_mask:0xf bank_mask:0xf
v_mov_b32 v43, v42
s_nop 1
v_permlane16_swap_b32 v42, v43
s_nop 1
v_max_f32 v42, v42, v43
v_mov_b32 v43, v42
s_nop 1
v_permlane32_swap_b32 v42, v43
s_nop 1
v_max_f32 v42, v42, v43
v_max_f32 v42, v42, v46
v_sub_f32 v43, v46, v42
v_mul_f32 v43, s57, v43
v_exp_f32 v43, v43
v_mov_b32 v46, v42
v_mul_f32 v3, s57, v42
v_sub_f32 v3, 0, v3
v_mul_f32 v47, v47, v43
v_mov_b32_dpp v44, v43 row_newbcast:0 row_mask:0x1 bank_mask:0xf
v_mov_b32_dpp v44, v43 row_newbcast:4 row_mask:0x2 bank_mask:0xf
v_mov_b32_dpp v44, v43 row_newbcast:8 row_mask:0x4 bank_mask:0xf
v_mov_b32_dpp v44, v43 row_newbcast:12 row_mask:0x8 bank_mask:0xf
v_mul_f32 v48, v48, v44
v_mul_f32 v49, v49, v44
v_mul_f32 v50, v50, v44
v_mul_f32 v51, v51, v44
v_mul_f32 v52, v52, v44
v_mul_f32 v53, v53, v44
v_mul_f32 v54, v54, v44
v_mul_f32 v55, v55, v44
L_grp_1:
v_fma_f32 v38, v38, s57, v3
v_fma_f32 v39, v39, s57, v3
v_fma_f32 v40, v40, s57, v3
v_fma_f32 v41, v41, s57, v3
v_exp_f32 v38, v38
v_exp_f32 v39, v39
v_exp_f32 v40, v40
v_exp_f32 v41, v41
s_nop 0
v_cvt_pk_bf16_f32 v56, v38, v38
v_cvt_pk_bf16_f32 v57, v39, v39
v_cvt_pk_bf16_f32 v58, v40, v40
v_cvt_pk_bf16_f32 v59, v41, v41
v_add_f32 v38, v38, v39
v_add_f32 v40, v40, v41
v_add_f32 v47, v47, v38
v_add_f32 v47, v47, v40
s_waitcnt vmcnt(36)
v_mfma_f32_16x16x32_bf16 v[20:23], v[128:131], v[4:7], 0
v_mfma_f32_16x16x32_bf16 v[20:23], v[132:135], v[8:11], v[20:23]
v_mfma_f32_16x16x32_bf16 v[20:23], v[136:139], v[12:15], v[20:23]
v_mfma_f32_16x16x32_bf16 v[20:23], v[140:143], v[16:19], v[20:23]
s_add_u32 s45, s44, 0x34000
buffer_load_dwordx4 v[96:99], v1, s[36:39], s45 offen offset:0 nt
buffer_load_dwordx4 v[100:103], v1, s[36:39], s45 offen offset:64 nt
buffer_load_dwordx4 v[104:107], v1, s[36:39], s45 offen offset:128 nt
buffer_load_dwordx4 v[108:111], v1, s[36:39], s45 offen offset:192 nt
v_and_b32_dpp v30, v56, v60 quad_perm:[0,0,0,0] row_mask:0xf bank_mask:0xf
v_and_b32_dpp v31, v56, v61 quad_perm:[0,0,0,0] row_mask:0xf bank_mask:0xf
v_and_b32_dpp v32, v57, v60 quad_perm:[0,0,0,0] row_mask:0xf bank_mask:0xf
v_and_b32_dpp v33, v57, v61 quad_perm:[0,0,0,0] row_mask:0xf bank_mask:0xf
v_and_b32_dpp v34, v58, v60 quad_perm:[0,0,0,0] row_mask:0xf bank_mask:0xf
v_and_b32_dpp v35, v58, v61 quad_perm:[0,0,0,0] row_mask:0xf bank_mask:0xf
v_and_b32_dpp v36, v59, v60 quad_perm:[0,0,0,0] row_mask:0xf bank_mask:0xf
v_and_b32_dpp v37, v59, v61 quad_perm:[0,0,0,0] row_mask:0xf bank_mask:0xf
s_waitcnt vmcnt(36)
s_nop 0
v_mfma_f32_16x16x16_bf16 v[48:51], v[30:31], v[144:145], v[48:51]
v_mfma_f32_16x16x16_bf16 v[52:55], v[30:31], v[146:147], v[52:55]
v_mfma_f32_16x16x16_bf16 v[48:51], v[32:33], v[148:149], v[48:51]
v_mfma_f32_16x16x16_bf16 v[52:55], v[32:33], v[150:151], v[52:55]
v_mfma_f32_16x16x16_bf16 v[48:51], v[34:35], v[152:153], v[48:51]
v_mfma_f32_16x16x16_bf16 v[52:55], v[34:35], v[154:155], v[52:55]
v_mfma_f32_16x16x16_bf16 v[48:51], v[36:37], v[156:157], v[48:51]
v_mfma_f32_16x16x16_bf16 v[52:55], v[36:37], v[158:159], v[52:55]
v_cvt_pk_bf16_f32 v28, v20, v21
v_cvt_pk_bf16_f32 v29, v22, v23
s_waitcnt vmcnt(32)
v_mfma_f32_16x16x32_bf16 v[24:27], v[160:163], v[4:7], 0
v_mfma_f32_16x16x32_bf16 v[24:27], v[164:167], v[8:11], v[24:27]
v_mfma_f32_16x16x32_bf16 v[24:27], v[168:171], v[12:15], v[24:27]
v_mfma_f32_16x16x32_bf16 v[24:27], v[172:175], v[16:19], v[24:27]
s_add_u32 s45, s44, 0x1e000
buffer_load_dwordx4 v[112:115], v2, s[40:43], s45 offen offset:0 nt
buffer_load_dwordx4 v[116:119], v2, s[40:43], s45 offen offset:1024 nt
buffer_load_dwordx4 v[120:123], v2, s[40:43], s45 offen offset:2048 nt
buffer_load_dwordx4 v[124:127], v2, s[40:43], s45 offen offset:3072 nt
v_and_b32_dpp v30, v56, v60 quad_perm:[1,1,1,1] row_mask:0xf bank_mask:0xf
v_and_b32_dpp v31, v56, v61 quad_perm:[1,1,1,1] row_mask:0xf bank_mask:0xf
v_and_b32_dpp v32, v57, v60 quad_perm:[1,1,1,1] row_mask:0xf bank_mask:0xf
v_and_b32_dpp v33, v57, v61 quad_perm:[1,1,1,1] row_mask:0xf bank_mask:0xf
v_and_b32_dpp v34, v58, v60 quad_perm:[1,1,1,1] row_mask:0xf bank_mask:0xf
v_and_b32_dpp v35, v58, v61 quad_perm:[1,1,1,1] row_mask:0xf bank_mask:0xf
v_and_b32_dpp v36, v59, v60 quad_perm:[1,1,1,1] row_mask:0xf bank_mask:0xf
v_and_b32_dpp v37, v59, v61 quad_perm:[1,1,1,1] row_mask:0xf bank_mask:0xf
s_waitcnt vmcnt(32)
s_nop 0
v_mfma_f32_16x16x16_bf16 v[48:51], v[30:31], v[176:177], v[48:51]
v_mfma_f32_16x16x16_bf16 v[52:55], v[30:31], v[178:179], v[52:55]
v_mfma_f32_16x16x16_bf16 v[48:51], v[32:33], v[180:181], v[48:51]
v_mfma_f32_16x16x16_bf16 v[52:55], v[32:33], v[182:183], v[52:55]
v_mfma_f32_16x16x16_bf16 v[48:51], v[34:35], v[184:185], v[48:51]
v_mfma_f32_16x16x16_bf16 v[52:55], v[34:35], v[186:187], v[52:55]
v_mfma_f32_16x16x16_bf16 v[48:51], v[36:37], v[188:189], v[48:51]
v_mfma_f32_16x16x16_bf16 v[52:55], v[36:37], v[190:191], v[52:55]
v_cvt_pk_bf16_f32 v62, v24, v25
v_cvt_pk_bf16_f32 v63, v26, v27
v_cndmask_b32 v28, v28, v62, s[50:51]
v_cndmask_b32 v29, v29, v63, s[50:51]
s_waitcnt vmcnt(28)
v_mfma_f32_16x16x32_bf16 v[20:23], v[192:195], v[4:7], 0
v_mfma_f32_16x16x32_bf16 v[20:23], v[196:199], v[8:11], v[20:23]
v_mfma_f32_16x16x32_bf16 v[20:23], v[200:203], v[12:15], v[20:23]
v_mfma_f32_16x16x32_bf16 v[20:23], v[204:207], v[16:19], v[20:23]
s_add_u32 s45, s44, 0x38000
buffer_load_dwordx4 v[128:131], v1, s[36:39], s45 offen offset:0 nt
buffer_load_dwordx4 v[132:135], v1, s[36:39], s45 offen offset:64 nt
buffer_load_dwordx4 v[136:139], v1, s[36:39], s45 offen offset:128 nt
buffer_load_dwordx4 v[140:143], v1, s[36:39], s45 offen offset:192 nt
v_and_b32_dpp v30, v56, v60 quad_perm:[2,2,2,2] row_mask:0xf bank_mask:0xf
v_and_b32_dpp v31, v56, v61 quad_perm:[2,2,2,2] row_mask:0xf bank_mask:0xf
v_and_b32_dpp v32, v57, v60 quad_perm:[2,2,2,2] row_mask:0xf bank_mask:0xf
v_and_b32_dpp v33, v57, v61 quad_perm:[2,2,2,2] row_mask:0xf bank_mask:0xf
v_and_b32_dpp v34, v58, v60 quad_perm:[2,2,2,2] row_mask:0xf bank_mask:0xf
v_and_b32_dpp v35, v58, v61 quad_perm:[2,2,2,2] row_mask:0xf bank_mask:0xf
v_and_b32_dpp v36, v59, v60 quad_perm:[2,2,2,2] row_mask:0xf bank_mask:0xf
v_and_b32_dpp v37, v59, v61 quad_perm:[2,2,2,2] row_mask:0xf bank_mask:0xf
s_waitcnt vmcnt(28)
s_nop 0
v_mfma_f32_16x16x16_bf16 v[48:51], v[30:31], v[208:209], v[48:51]
v_mfma_f32_16x16x16_bf16 v[52:55], v[30:31], v[210:211], v[52:55]
v_mfma_f32_16x16x16_bf16 v[48:51], v[32:33], v[212:213], v[48:51]
v_mfma_f32_16x16x16_bf16 v[52:55], v[32:33], v[214:215], v[52:55]
v_mfma_f32_16x16x16_bf16 v[48:51], v[34:35], v[216:217], v[48:51]
v_mfma_f32_16x16x16_bf16 v[52:55], v[34:35], v[218:219], v[52:55]
v_mfma_f32_16x16x16_bf16 v[48:51], v[36:37], v[220:221], v[48:51]
v_mfma_f32_16x16x16_bf16 v[52:55], v[36:37], v[222:223], v[52:55]
s_add_u32 s45, s44, 0x24000
buffer_load_dwordx4 v[144:147], v2, s[40:43], s45 offen offset:0 nt
buffer_load_dwordx4 v[148:151], v2, s[40:43], s45 offen offset:1024 nt
buffer_load_dwordx4 v[152:155], v2, s[40:43], s45 offen offset:2048 nt
buffer_load_dwordx4 v[156:159], v2, s[40:43], s45 offen offset:3072 nt
v_cvt_pk_bf16_f32 v62, v20, v21
v_cvt_pk_bf16_f32 v63, v22, v23
v_cndmask_b32 v28, v28, v62, s[52:53]
v_cndmask_b32 v29, v29, v63, s[52:53]
s_waitcnt vmcnt(28)
v_mfma_f32_16x16x32_bf16 v[24:27], v[224:227], v[4:7], 0
v_mfma_f32_16x16x32_bf16 v[24:27], v[228:231], v[8:11], v[24:27]
v_mfma_f32_16x16x32_bf16 v[24:27], v[232:235], v[12:15], v[24:27]
v_mfma_f32_16x16x32_bf16 v[24:27], v[236:239], v[16:19], v[24:27]
s_add_u32 s45, s44, 0x3c000
buffer_load_dwordx4 v[160:163], v1, s[36:39], s45 offen offset:0 nt
buffer_load_dwordx4 v[164:167], v1, s[36:39], s45 offen offset:64 nt
buffer_load_dwordx4 v[168:171], v1, s[36:39], s45 offen offset:128 nt
buffer_load_dwordx4 v[172:175], v1, s[36:39], s45 offen offset:192 nt
v_and_b32_dpp v30, v56, v60 quad_perm:[3,3,3,3] row_mask:0xf bank_mask:0xf
v_and_b32_dpp v31, v56, v61 quad_perm:[3,3,3,3] row_mask:0xf bank_mask:0xf
v_and_b32_dpp v32, v57, v60 quad_perm:[3,3,3,3] row_mask:0xf bank_mask:0xf
v_and_b32_dpp v33, v57, v61 quad_perm:[3,3,3,3] row_mask:0xf bank_mask:0xf
v_and_b32_dpp v34, v58, v60 quad_perm:[3,3,3,3] row_mask:0xf bank_mask:0xf
v_and_b32_dpp v35, v58, v61 quad_perm:[3,3,3,3] row_mask:0xf bank_mask:0xf
v_and_b32_dpp v36, v59, v60 quad_perm:[3,3,3,3] row_mask:0xf bank_mask:0xf
v_and_b32_dpp v37, v59, v61 quad_perm:[3,3,3,3] row_mask:0xf bank_mask:0xf
s_waitcnt vmcnt(28)
s_nop 0
v_mfma_f32_16x16x16_bf16 v[48:51], v[30:31], v[240:241], v[48:51]
v_mfma_f32_16x16x16_bf16 v[52:55], v[30:31], v[242:243], v[52:55]
v_mfma_f32_16x16x16_bf16 v[48:51], v[32:33], v[244:245], v[48:51]
v_mfma_f32_16x16x16_bf16 v[52:55], v[32:33], v[246:247], v[52:55]
v_mfma_f32_16x16x16_bf16 v[48:51], v[34:35], v[248:249], v[48:51]
v_mfma_f32_16x16x16_bf16 v[52:55], v[34:35], v[250:251], v[52:55]
v_mfma_f32_16x16x16_bf16 v[48:51], v[36:37], v[252:253], v[48:51]
v_mfma_f32_16x16x16_bf16 v[52:55], v[36:37], v[254:255], v[52:55]
s_add_u32 s45, s44, 0x2a000
buffer_load_dwordx4 v[176:179], v2, s[40:43], s45 offen offset:0 nt
buffer_load_dwordx4 v[180:183], v2, s[40:43], s45 offen offset:1024 nt
buffer_load_dwordx4 v[184:187], v2, s[40:43], s45 offen offset:2048 nt
buffer_load_dwordx4 v[188:191], v2, s[40:43], s45 offen offset:3072 nt
v_cvt_pk_bf16_f32 v62, v24, v25
v_cvt_pk_bf16_f32 v63, v26, v27
v_cndmask_b32 v28, v28, v62, s[54:55]
v_cndmask_b32 v29, v29, v63, s[54:55]
v_lshlrev_b32 v38, 16, v28
v_and_b32 v39, 0xffff0000, v28
v_lshlrev_b32 v40, 16, v29
v_and_b32 v41, 0xffff0000, v29
v_mul_f32 v38, s56, v38
v_mul_f32 v39, s56, v39
v_mul_f32 v40, s56, v40
v_mul_f32 v41, s56, v41
v_cvt_pk_bf16_f32 v42, v38, v39
v_lshlrev_b32 v38, 16, v42
v_and_b32 v39, 0xffff0000, v42
v_cvt_pk_bf16_f32 v43, v40, v41
v_lshlrev_b32 v40, 16, v43
v_and_b32 v41, 0xffff0000, v43
v_max3_f32 v42, v38, v39, v40
v_max_f32 v42, v42, v41
v_cmp_gt_f32 vcc, v42, v46
s_cbranch_vccz L_grp_2
s_nop 1
v_max_f32_dpp v42, v42, v42 quad_perm:[1,0,3,2] row_mask:0xf bank_mask:0xf
s_nop 1
v_max_f32_dpp v42, v42, v42 quad_perm:[2,3,0,1] row_mask:0xf bank_mask:0xf
v_mov_b32 v43, v42
s_nop 1
v_permlane16_swap_b32 v42, v43
s_nop 1
v_max_f32 v42, v42, v43
v_mov_b32 v43, v42
s_nop 1
v_permlane32_swap_b32 v42, v43
s_nop 1
v_max_f32 v42, v42, v43
v_max_f32 v42, v42, v46
v_sub_f32 v43, v46, v42
v_mul_f32 v43, s57, v43
v_exp_f32 v43, v43
v_mov_b32 v46, v42
v_mul_f32 v3, s57, v42
v_sub_f32 v3, 0, v3
v_mul_f32 v47, v47, v43
v_mov_b32_dpp v44, v43 row_newbcast:0 row_mask:0x1 bank_mask:0xf
v_mov_b32_dpp v44, v43 row_newbcast:4 row_mask:0x2 bank_mask:0xf
v_mov_b32_dpp v44, v43 row_newbcast:8 row_mask:0x4 bank_mask:0xf
v_mov_b32_dpp v44, v43 row_newbcast:12 row_mask:0x8 bank_mask:0xf
v_mul_f32 v48, v48, v44
v_mul_f32 v49, v49, v44
v_mul_f32 v50, v50, v44
v_mul_f32 v51, v51, v44
v_mul_f32 v52, v52, v44
v_mul_f32 v53, v53, v44
v_mul_f32 v54, v54, v44
v_mul_f32 v55, v55, v44
L_grp_2:
v_fma_f32 v38, v38, s57, v3
v_fma_f32 v39, v39, s57, v3
v_fma_f32 v40, v40, s57, v3
v_fma_f32 v41, v41, s57, v3
v_exp_f32 v38, v38
v_exp_f32 v39, v39
v_exp_f32 v40, v40
v_exp_f32 v41, v41
s_nop 0
v_cvt_pk_bf16_f32 v56, v38, v38
v_cvt_pk_bf16_f32 v57, v39, v39
v_cvt_pk_bf16_f32 v58, v40, v40
v_cvt_pk_bf16_f32 v59, v41, v41
v_add_f32 v38, v38, v39
v_add_f32 v40, v40, v41
v_add_f32 v47, v47, v38
v_add_f32 v47, v47, v40
s_waitcnt vmcnt(28)
v_mfma_f32_16x16x32_bf16 v[20:23], v[64:67], v[4:7], 0
v_mfma_f32_16x16x32_bf16 v[20:23], v[68:71], v[8:11], v[20:23]
v_mfma_f32_16x16x32_bf16 v[20:23], v[72:75], v[12:15], v[20:23]
v_mfma_f32_16x16x32_bf16 v[20:23], v[76:79], v[16:19], v[20:23]
s_add_u32 s45, s44, 0x40000
buffer_load_dwordx4 v[192:195], v1, s[36:39], s45 offen offset:0 nt
buffer_load_dwordx4 v[196:199], v1, s[36:39], s45 offen offset:64 nt
buffer_load_dwordx4 v[200:203], v1, s[36:39], s45 offen offset:128 nt
buffer_load_dwordx4 v[204:207], v1, s[36:39], s45 offen offset:192 nt
v_and_b32_dpp v30, v56, v60 quad_perm:[0,0,0,0] row_mask:0xf bank_mask:0xf
v_and_b32_dpp v31, v56, v61 quad_perm:[0,0,0,0] row_mask:0xf bank_mask:0xf
v_and_b32_dpp v32, v57, v60 quad_perm:[0,0,0,0] row_mask:0xf bank_mask:0xf
v_and_b32_dpp v33, v57, v61 quad_perm:[0,0,0,0] row_mask:0xf bank_mask:0xf
v_and_b32_dpp v34, v58, v60 quad_perm:[0,0,0,0] row_mask:0xf bank_mask:0xf
v_and_b32_dpp v35, v58, v61 quad_perm:[0,0,0,0] row_mask:0xf bank_mask:0xf
v_and_b32_dpp v36, v59, v60 quad_perm:[0,0,0,0] row_mask:0xf bank_mask:0xf
v_and_b32_dpp v37, v59, v61 quad_perm:[0,0,0,0] row_mask:0xf bank_mask:0xf
s_waitcnt vmcnt(28)
s_nop 0
v_mfma_f32_16x16x16_bf16 v[48:51], v[30:31], v[80:81], v[48:51]
v_mfma_f32_16x16x16_bf16 v[52:55], v[30:31], v[82:83], v[52:55]
v_mfma_f32_16x16x16_bf16 v[48:51], v[32:33], v[84:85], v[48:51]
v_mfma_f32_16x16x16_bf16 v[52:55], v[32:33], v[86:87], v[52:55]
v_mfma_f32_16x16x16_bf16 v[48:51], v[34:35], v[88:89], v[48:51]
v_mfma_f32_16x16x16_bf16 v[52:55], v[34:35], v[90:91], v[52:55]
v_mfma_f32_16x16x16_bf16 v[48:51], v[36:37], v[92:93], v[48:51]
v_mfma_f32_16x16x16_bf16 v[52:55], v[36:37], v[94:95], v[52:55]
s_add_u32 s45, s44, 0x30000
buffer_load_dwordx4 v[208:211], v2, s[40:43], s45 offen offset:0 nt
buffer_load_dwordx4 v[212:215], v2, s[40:43], s45 offen offset:1024 nt
buffer_load_dwordx4 v[216:219], v2, s[40:43], s45 offen offset:2048 nt
buffer_load_dwordx4 v[220:223], v2, s[40:43], s45 offen offset:3072 nt
v_cvt_pk_bf16_f32 v28, v20, v21
v_cvt_pk_bf16_f32 v29, v22, v23
s_waitcnt vmcnt(28)
v_mfma_f32_16x16x32_bf16 v[24:27], v[96:99], v[4:7], 0
v_mfma_f32_16x16x32_bf16 v[24:27], v[100:103], v[8:11], v[24:27]
v_mfma_f32_16x16x32_bf16 v[24:27], v[104:107], v[12:15], v[24:27]
v_mfma_f32_16x16x32_bf16 v[24:27], v[108:111], v[16:19], v[24:27]
s_add_u32 s45, s44, 0x44000
buffer_load_dwordx4 v[224:227], v1, s[36:39], s45 offen offset:0 nt
buffer_load_dwordx4 v[228:231], v1, s[36:39], s45 offen offset:64 nt
buffer_load_dwordx4 v[232:235], v1, s[36:39], s45 offen offset:128 nt
buffer_load_dwordx4 v[236:239], v1, s[36:39], s45 offen offset:192 nt
v_and_b32_dpp v30, v56, v60 quad_perm:[1,1,1,1] row_mask:0xf bank_mask:0xf
v_and_b32_dpp v31, v56, v61 quad_perm:[1,1,1,1] row_mask:0xf bank_mask:0xf
v_and_b32_dpp v32, v57, v60 quad_perm:[1,1,1,1] row_mask:0xf bank_mask:0xf
v_and_b32_dpp v33, v57, v61 quad_perm:[1,1,1,1] row_mask:0xf bank_mask:0xf
v_and_b32_dpp v34, v58, v60 quad_perm:[1,1,1,1] row_mask:0xf bank_mask:0xf
v_and_b32_dpp v35, v58, v61 quad_perm:[1,1,1,1] row_mask:0xf bank_mask:0xf
v_and_b32_dpp v36, v59, v60 quad_perm:[1,1,1,1] row_mask:0xf bank_mask:0xf
v_and_b32_dpp v37, v59, v61 quad_perm:[1,1,1,1] row_mask:0xf bank_mask:0xf
s_waitcnt vmcnt(28)
s_nop 0
v_mfma_f32_16x16x16_bf16 v[48:51], v[30:31], v[112:113], v[48:51]
v_mfma_f32_16x16x16_bf16 v[52:55], v[30:31], v[114:115], v[52:55]
v_mfma_f32_16x16x16_bf16 v[48:51], v[32:33], v[116:117], v[48:51]
v_mfma_f32_16x16x16_bf16 v[52:55], v[32:33], v[118:119], v[52:55]
v_mfma_f32_16x16x16_bf16 v[48:51], v[34:35], v[120:121], v[48:51]
v_mfma_f32_16x16x16_bf16 v[52:55], v[34:35], v[122:123], v[52:55]
v_mfma_f32_16x16x16_bf16 v[48:51], v[36:37], v[124:125], v[48:51]
v_mfma_f32_16x16x16_bf16 v[52:55], v[36:37], v[126:127], v[52:55]
s_add_u32 s45, s44, 0x34000
buffer_load_dwordx4 v[240:243], v2, s[40:43], s45 offen offset:0 nt
buffer_load_dwordx4 v[244:247], v2, s[40:43], s45 offen offset:1024 nt
buffer_load_dwordx4 v[248:251], v2, s[40:43], s45 offen offset:2048 nt
buffer_load_dwordx4 v[252:255], v2, s[40:43], s45 offen offset:3072 nt
v_cvt_pk_bf16_f32 v62, v24, v25
v_cvt_pk_bf16_f32 v63, v26, v27
v_cndmask_b32 v28, v28, v62, s[50:51]
v_cndmask_b32 v29, v29, v63, s[50:51]
s_waitcnt vmcnt(28)
v_mfma_f32_16x16x32_bf16 v[20:23], v[128:131], v[4:7], 0
v_mfma_f32_16x16x32_bf16 v[20:23], v[132:135], v[8:11], v[20:23]
v_mfma_f32_16x16x32_bf16 v[20:23], v[136:139], v[12:15], v[20:23]
v_mfma_f32_16x16x32_bf16 v[20:23], v[140:143], v[16:19], v[20:23]
s_add_u32 s45, s44, 0x48000
buffer_load_dwordx4 v[64:67], v1, s[36:39], s45 offen offset:0 nt
buffer_load_dwordx4 v[68:71], v1, s[36:39], s45 offen offset:64 nt
buffer_load_dwordx4 v[72:75], v1, s[36:39], s45 offen offset:128 nt
buffer_load_dwordx4 v[76:79], v1, s[36:39], s45 offen offset:192 nt
v_and_b32_dpp v30, v56, v60 quad_perm:[2,2,2,2] row_mask:0xf bank_mask:0xf
v_and_b32_dpp v31, v56, v61 quad_perm:[2,2,2,2] row_mask:0xf bank_mask:0xf
v_and_b32_dpp v32, v57, v60 quad_perm:[2,2,2,2] row_mask:0xf bank_mask:0xf
v_and_b32_dpp v33, v57, v61 quad_perm:[2,2,2,2] row_mask:0xf bank_mask:0xf
v_and_b32_dpp v34, v58, v60 quad_perm:[2,2,2,2] row_mask:0xf bank_mask:0xf
v_and_b32_dpp v35, v58, v61 quad_perm:[2,2,2,2] row_mask:0xf bank_mask:0xf
v_and_b32_dpp v36, v59, v60 quad_perm:[2,2,2,2] row_mask:0xf bank_mask:0xf
v_and_b32_dpp v37, v59, v61 quad_perm:[2,2,2,2] row_mask:0xf bank_mask:0xf
s_waitcnt vmcnt(28)
s_nop 0
v_mfma_f32_16x16x16_bf16 v[48:51], v[30:31], v[144:145], v[48:51]
v_mfma_f32_16x16x16_bf16 v[52:55], v[30:31], v[146:147], v[52:55]
v_mfma_f32_16x16x16_bf16 v[48:51], v[32:33], v[148:149], v[48:51]
v_mfma_f32_16x16x16_bf16 v[52:55], v[32:33], v[150:151], v[52:55]
v_mfma_f32_16x16x16_bf16 v[48:51], v[34:35], v[152:153], v[48:51]
v_mfma_f32_16x16x16_bf16 v[52:55], v[34:35], v[154:155], v[52:55]
v_mfma_f32_16x16x16_bf16 v[48:51], v[36:37], v[156:157], v[48:51]
v_mfma_f32_16x16x16_bf16 v[52:55], v[36:37], v[158:159], v[52:55]
s_add_u32 s45, s44, 0x38000
buffer_load_dwordx4 v[80:83], v2, s[40:43], s45 offen offset:0 nt
buffer_load_dwordx4 v[84:87], v2, s[40:43], s45 offen offset:1024 nt
buffer_load_dwordx4 v[88:91], v2, s[40:43], s45 offen offset:2048 nt
buffer_load_dwordx4 v[92:95], v2, s[40:43], s45 offen offset:3072 nt
v_cvt_pk_bf16_f32 v62, v20, v21
v_cvt_pk_bf16_f32 v63, v22, v23
v_cndmask_b32 v28, v28, v62, s[52:53]
v_cndmask_b32 v29, v29, v63, s[52:53]
s_waitcnt vmcnt(28)
v_mfma_f32_16x16x32_bf16 v[24:27], v[160:163], v[4:7], 0
v_mfma_f32_16x16x32_bf16 v[24:27], v[164:167], v[8:11], v[24:27]
v_mfma_f32_16x16x32_bf16 v[24:27], v[168:171], v[12:15], v[24:27]
v_mfma_f32_16x16x32_bf16 v[24:27], v[172:175], v[16:19], v[24:27]
s_add_u32 s45, s44, 0x4c000
buffer_load_dwordx4 v[96:99], v1, s[36:39], s45 offen offset:0 nt
buffer_load_dwordx4 v[100:103], v1, s[36:39], s45 offen offset:64 nt
buffer_load_dwordx4 v[104:107], v1, s[36:39], s45 offen offset:128 nt
buffer_load_dwordx4 v[108:111], v1, s[36:39], s45 offen offset:192 nt
v_and_b32_dpp v30, v56, v60 quad_perm:[3,3,3,3] row_mask:0xf bank_mask:0xf
v_and_b32_dpp v31, v56, v61 quad_perm:[3,3,3,3] row_mask:0xf bank_mask:0xf
v_and_b32_dpp v32, v57, v60 quad_perm:[3,3,3,3] row_mask:0xf bank_mask:0xf
v_and_b32_dpp v33, v57, v61 quad_perm:[3,3,3,3] row_mask:0xf bank_mask:0xf
v_and_b32_dpp v34, v58, v60 quad_perm:[3,3,3,3] row_mask:0xf bank_mask:0xf
v_and_b32_dpp v35, v58, v61 quad_perm:[3,3,3,3] row_mask:0xf bank_mask:0xf
v_and_b32_dpp v36, v59, v60 quad_perm:[3,3,3,3] row_mask:0xf bank_mask:0xf
v_and_b32_dpp v37, v59, v61 quad_perm:[3,3,3,3] row_mask:0xf bank_mask:0xf
s_waitcnt vmcnt(28)
s_nop 0
v_mfma_f32_16x16x16_bf16 v[48:51], v[30:31], v[176:177], v[48:51]
v_mfma_f32_16x16x16_bf16 v[52:55], v[30:31], v[178:179], v[52:55]
v_mfma_f32_16x16x16_bf16 v[48:51], v[32:33], v[180:181], v[48:51]
v_mfma_f32_16x16x16_bf16 v[52:55], v[32:33], v[182:183], v[52:55]
v_mfma_f32_16x16x16_bf16 v[48:51], v[34:35], v[184:185], v[48:51]
v_mfma_f32_16x16x16_bf16 v[52:55], v[34:35], v[186:187], v[52:55]
v_mfma_f32_16x16x16_bf16 v[48:51], v[36:37], v[188:189], v[48:51]
v_mfma_f32_16x16x16_bf16 v[52:55], v[36:37], v[190:191], v[52:55]
s_add_u32 s45, s44, 0x3c000
buffer_load_dwordx4 v[112:115], v2, s[40:43], s45 offen offset:0 nt
buffer_load_dwordx4 v[116:119], v2, s[40:43], s45 offen offset:1024 nt
buffer_load_dwordx4 v[120:123], v2, s[40:43], s45 offen offset:2048 nt
buffer_load_dwordx4 v[124:127], v2, s[40:43], s45 offen offset:3072 nt
v_cvt_pk_bf16_f32 v62, v24, v25
v_cvt_pk_bf16_f32 v63, v26, v27
v_cndmask_b32 v28, v28, v62, s[54:55]
v_cndmask_b32 v29, v29, v63, s[54:55]
v_lshlrev_b32 v38, 16, v28
v_and_b32 v39, 0xffff0000, v28
v_lshlrev_b32 v40, 16, v29
v_and_b32 v41, 0xffff0000, v29
v_mul_f32 v38, s56, v38
v_mul_f32 v39, s56, v39
v_mul_f32 v40, s56, v40
v_mul_f32 v41, s56, v41
v_cvt_pk_bf16_f32 v42, v38, v39
v_lshlrev_b32 v38, 16, v42
v_and_b32 v39, 0xffff0000, v42
v_cvt_pk_bf16_f32 v43, v40, v41
v_lshlrev_b32 v40, 16, v43
v_and_b32 v41, 0xffff0000, v43
v_max3_f32 v42, v38, v39, v40
v_max_f32 v42, v42, v41
v_cmp_gt_f32 vcc, v42, v46
s_cbranch_vccz L_grp_3
s_nop 1
v_max_f32_dpp v42, v42, v42 quad_perm:[1,0,3,2] row_mask:0xf bank_mask:0xf
s_nop 1
v_max_f32_dpp v42, v42, v42 quad_perm:[2,3,0,1] row_mask:0xf bank_mask:0xf
v_mov_b32 v43, v42
s_nop 1
v_permlane16_swap_b32 v42, v43
s_nop 1
v_max_f32 v42, v42, v43
v_mov_b32 v43, v42
s_nop 1
v_permlane32_swap_b32 v42, v43
s_nop 1
v_max_f32 v42, v42, v43
v_max_f32 v42, v42, v46
v_sub_f32 v43, v46, v42
v_mul_f32 v43, s57, v43
v_exp_f32 v43, v43
v_mov_b32 v46, v42
v_mul_f32 v3, s57, v42
v_sub_f32 v3, 0, v3
v_mul_f32 v47, v47, v43
v_mov_b32_dpp v44, v43 row_newbcast:0 row_mask:0x1 bank_mask:0xf
v_mov_b32_dpp v44, v43 row_newbcast:4 row_mask:0x2 bank_mask:0xf
v_mov_b32_dpp v44, v43 row_newbcast:8 row_mask:0x4 bank_mask:0xf
v_mov_b32_dpp v44, v43 row_newbcast:12 row_mask:0x8 bank_mask:0xf
v_mul_f32 v48, v48, v44
v_mul_f32 v49, v49, v44
v_mul_f32 v50, v50, v44
v_mul_f32 v51, v51, v44
v_mul_f32 v52, v52, v44
v_mul_f32 v53, v53, v44
v_mul_f32 v54, v54, v44
v_mul_f32 v55, v55, v44
L_grp_3:
v_fma_f32 v38, v38, s57, v3
v_fma_f32 v39, v39, s57, v3
v_fma_f32 v40, v40, s57, v3
v_fma_f32 v41, v41, s57, v3
v_exp_f32 v38, v38
v_exp_f32 v39, v39
v_exp_f32 v40, v40
v_exp_f32 v41, v41
s_nop 0
v_cvt_pk_bf16_f32 v56, v38, v38
v_cvt_pk_bf16_f32 v57, v39, v39
v_cvt_pk_bf16_f32 v58, v40, v40
v_cvt_pk_bf16_f32 v59, v41, v41
v_add_f32 v38, v38, v39
v_add_f32 v40, v40, v41
v_add_f32 v47, v47, v38
v_add_f32 v47, v47, v40
s_waitcnt vmcnt(28)
v_mfma_f32_16x16x32_bf16 v[20:23], v[192:195], v[4:7], 0
v_mfma_f32_16x16x32_bf16 v[20:23], v[196:199], v[8:11], v[20:23]
v_mfma_f32_16x16x32_bf16 v[20:23], v[200:203], v[12:15], v[20:23]
v_mfma_f32_16x16x32_bf16 v[20:23], v[204:207], v[16:19], v[20:23]
s_add_u32 s45, s44, 0x50000
buffer_load_dwordx4 v[128:131], v1, s[36:39], s45 offen offset:0 nt
buffer_load_dwordx4 v[132:135], v1, s[36:39], s45 offen offset:64 nt
buffer_load_dwordx4 v[136:139], v1, s[36:39], s45 offen offset:128 nt
buffer_load_dwordx4 v[140:143], v1, s[36:39], s45 offen offset:192 nt
v_and_b32_dpp v30, v56, v60 quad_perm:[0,0,0,0] row_mask:0xf bank_mask:0xf
v_and_b32_dpp v31, v56, v61 quad_perm:[0,0,0,0] row_mask:0xf bank_mask:0xf
v_and_b32_dpp v32, v57, v60 quad_perm:[0,0,0,0] row_mask:0xf bank_mask:0xf
v_and_b32_dpp v33, v57, v61 quad_perm:[0,0,0,0] row_mask:0xf bank_mask:0xf
v_and_b32_dpp v34, v58, v60 quad_perm:[0,0,0,0] row_mask:0xf bank_mask:0xf
v_and_b32_dpp v35, v58, v61 quad_perm:[0,0,0,0] row_mask:0xf bank_mask:0xf
v_and_b32_dpp v36, v59, v60 quad_perm:[0,0,0,0] row_mask:0xf bank_mask:0xf
v_and_b32_dpp v37, v59, v61 quad_perm:[0,0,0,0] row_mask:0xf bank_mask:0xf
s_waitcnt vmcnt(28)
s_nop 0
v_mfma_f32_16x16x16_bf16 v[48:51], v[30:31], v[208:209], v[48:51]
v_mfma_f32_16x16x16_bf16 v[52:55], v[30:31], v[210:211], v[52:55]
v_mfma_f32_16x16x16_bf16 v[48:51], v[32:33], v[212:213], v[48:51]
v_mfma_f32_16x16x16_bf16 v[52:55], v[32:33], v[214:215], v[52:55]
v_mfma_f32_16x16x16_bf16 v[48:51], v[34:35], v[216:217], v[48:51]
v_mfma_f32_16x16x16_bf16 v[52:55], v[34:35], v[218:219], v[52:55]
v_mfma_f32_16x16x16_bf16 v[48:51], v[36:37], v[220:221], v[48:51]
v_mfma_f32_16x16x16_bf16 v[52:55], v[36:37], v[222:223], v[52:55]
s_add_u32 s45, s44, 0x40000
buffer_load_dwordx4 v[144:147], v2, s[40:43], s45 offen offset:0 nt
buffer_load_dwordx4 v[148:151], v2, s[40:43], s45 offen offset:1024 nt
buffer_load_dwordx4 v[152:155], v2, s[40:43], s45 offen offset:2048 nt
buffer_load_dwordx4 v[156:159], v2, s[40:43], s45 offen offset:3072 nt
v_cvt_pk_bf16_f32 v28, v20, v21
v_cvt_pk_bf16_f32 v29, v22, v23
s_waitcnt vmcnt(28)
v_mfma_f32_16x16x32_bf16 v[24:27], v[224:227], v[4:7], 0
v_mfma_f32_16x16x32_bf16 v[24:27], v[228:231], v[8:11], v[24:27]
v_mfma_f32_16x16x32_bf16 v[24:27], v[232:235], v[12:15], v[24:27]
v_mfma_f32_16x16x32_bf16 v[24:27], v[236:239], v[16:19], v[24:27]
s_add_u32 s45, s44, 0x54000
buffer_load_dwordx4 v[160:163], v1, s[36:39], s45 offen offset:0 nt
buffer_load_dwordx4 v[164:167], v1, s[36:39], s45 offen offset:64 nt
buffer_load_dwordx4 v[168:171], v1, s[36:39], s45 offen offset:128 nt
buffer_load_dwordx4 v[172:175], v1, s[36:39], s45 offen offset:192 nt
v_and_b32_dpp v30, v56, v60 quad_perm:[1,1,1,1] row_mask:0xf bank_mask:0xf
v_and_b32_dpp v31, v56, v61 quad_perm:[1,1,1,1] row_mask:0xf bank_mask:0xf
v_and_b32_dpp v32, v57, v60 quad_perm:[1,1,1,1] row_mask:0xf bank_mask:0xf
v_and_b32_dpp v33, v57, v61 quad_perm:[1,1,1,1] row_mask:0xf bank_mask:0xf
v_and_b32_dpp v34, v58, v60 quad_perm:[1,1,1,1] row_mask:0xf bank_mask:0xf
v_and_b32_dpp v35, v58, v61 quad_perm:[1,1,1,1] row_mask:0xf bank_mask:0xf
v_and_b32_dpp v36, v59, v60 quad_perm:[1,1,1,1] row_mask:0xf bank_mask:0xf
v_and_b32_dpp v37, v59, v61 quad_perm:[1,1,1,1] row_mask:0xf bank_mask:0xf
s_waitcnt vmcnt(28)
s_nop 0
v_mfma_f32_16x16x16_bf16 v[48:51], v[30:31], v[240:241], v[48:51]
v_mfma_f32_16x16x16_bf16 v[52:55], v[30:31], v[242:243], v[52:55]
v_mfma_f32_16x16x16_bf16 v[48:51], v[32:33], v[244:245], v[48:51]
v_mfma_f32_16x16x16_bf16 v[52:55], v[32:33], v[246:247], v[52:55]
v_mfma_f32_16x16x16_bf16 v[48:51], v[34:35], v[248:249], v[48:51]
v_mfma_f32_16x16x16_bf16 v[52:55], v[34:35], v[250:251], v[52:55]
v_mfma_f32_16x16x16_bf16 v[48:51], v[36:37], v[252:253], v[48:51]
v_mfma_f32_16x16x16_bf16 v[52:55], v[36:37], v[254:255], v[52:55]
s_add_u32 s45, s44, 0x44000
buffer_load_dwordx4 v[176:179], v2, s[40:43], s45 offen offset:0 nt
buffer_load_dwordx4 v[180:183], v2, s[40:43], s45 offen offset:1024 nt
buffer_load_dwordx4 v[184:187], v2, s[40:43], s45 offen offset:2048 nt
buffer_load_dwordx4 v[188:191], v2, s[40:43], s45 offen offset:3072 nt
v_cvt_pk_bf16_f32 v62, v24, v25
v_cvt_pk_bf16_f32 v63, v26, v27
v_cndmask_b32 v28, v28, v62, s[50:51]
v_cndmask_b32 v29, v29, v63, s[50:51]
s_waitcnt vmcnt(28)
v_mfma_f32_16x16x32_bf16 v[20:23], v[64:67], v[4:7], 0
v_mfma_f32_16x16x32_bf16 v[20:23], v[68:71], v[8:11], v[20:23]
v_mfma_f32_16x16x32_bf16 v[20:23], v[72:75], v[12:15], v[20:23]
v_mfma_f32_16x16x32_bf16 v[20:23], v[76:79], v[16:19], v[20:23]
s_add_u32 s45, s44, 0x58000
buffer_load_dwordx4 v[192:195], v1, s[36:39], s45 offen offset:0 nt
buffer_load_dwordx4 v[196:199], v1, s[36:39], s45 offen offset:64 nt
buffer_load_dwordx4 v[200:203], v1, s[36:39], s45 offen offset:128 nt
buffer_load_dwordx4 v[204:207], v1, s[36:39], s45 offen offset:192 nt
v_and_b32_dpp v30, v56, v60 quad_perm:[2,2,2,2] row_mask:0xf bank_mask:0xf
v_and_b32_dpp v31, v56, v61 quad_perm:[2,2,2,2] row_mask:0xf bank_mask:0xf
v_and_b32_dpp v32, v57, v60 quad_perm:[2,2,2,2] row_mask:0xf bank_mask:0xf
v_and_b32_dpp v33, v57, v61 quad_perm:[2,2,2,2] row_mask:0xf bank_mask:0xf
v_and_b32_dpp v34, v58, v60 quad_perm:[2,2,2,2] row_mask:0xf bank_mask:0xf
v_and_b32_dpp v35, v58, v61 quad_perm:[2,2,2,2] row_mask:0xf bank_mask:0xf
v_and_b32_dpp v36, v59, v60 quad_perm:[2,2,2,2] row_mask:0xf bank_mask:0xf
v_and_b32_dpp v37, v59, v61 quad_perm:[2,2,2,2] row_mask:0xf bank_mask:0xf
s_waitcnt vmcnt(28)
s_nop 0
v_mfma_f32_16x16x16_bf16 v[48:51], v[30:31], v[80:81], v[48:51]
v_mfma_f32_16x16x16_bf16 v[52:55], v[30:31], v[82:83], v[52:55]
v_mfma_f32_16x16x16_bf16 v[48:51], v[32:33], v[84:85], v[48:51]
v_mfma_f32_16x16x16_bf16 v[52:55], v[32:33], v[86:87], v[52:55]
v_mfma_f32_16x16x16_bf16 v[48:51], v[34:35], v[88:89], v[48:51]
v_mfma_f32_16x16x16_bf16 v[52:55], v[34:35], v[90:91], v[52:55]
v_mfma_f32_16x16x16_bf16 v[48:51], v[36:37], v[92:93], v[48:51]
v_mfma_f32_16x16x16_bf16 v[52:55], v[36:37], v[94:95], v[52:55]
s_add_u32 s45, s44, 0x48000
buffer_load_dwordx4 v[208:211], v2, s[40:43], s45 offen offset:0 nt
buffer_load_dwordx4 v[212:215], v2, s[40:43], s45 offen offset:1024 nt
buffer_load_dwordx4 v[216:219], v2, s[40:43], s45 offen offset:2048 nt
buffer_load_dwordx4 v[220:223], v2, s[40:43], s45 offen offset:3072 nt
v_cvt_pk_bf16_f32 v62, v20, v21
v_cvt_pk_bf16_f32 v63, v22, v23
v_cndmask_b32 v28, v28, v62, s[52:53]
v_cndmask_b32 v29, v29, v63, s[52:53]
s_waitcnt vmcnt(28)
v_mfma_f32_16x16x32_bf16 v[24:27], v[96:99], v[4:7], 0
v_mfma_f32_16x16x32_bf16 v[24:27], v[100:103], v[8:11], v[24:27]
v_mfma_f32_16x16x32_bf16 v[24:27], v[104:107], v[12:15], v[24:27]
v_mfma_f32_16x16x32_bf16 v[24:27], v[108:111], v[16:19], v[24:27]
s_add_u32 s45, s44, 0x5c000
buffer_load_dwordx4 v[224:227], v1, s[36:39], s45 offen offset:0 nt
buffer_load_dwordx4 v[228:231], v1, s[36:39], s45 offen offset:64 nt
buffer_load_dwordx4 v[232:235], v1, s[36:39], s45 offen offset:128 nt
buffer_load_dwordx4 v[236:239], v1, s[36:39], s45 offen offset:192 nt
v_and_b32_dpp v30, v56, v60 quad_perm:[3,3,3,3] row_mask:0xf bank_mask:0xf
v_and_b32_dpp v31, v56, v61 quad_perm:[3,3,3,3] row_mask:0xf bank_mask:0xf
v_and_b32_dpp v32, v57, v60 quad_perm:[3,3,3,3] row_mask:0xf bank_mask:0xf
v_and_b32_dpp v33, v57, v61 quad_perm:[3,3,3,3] row_mask:0xf bank_mask:0xf
v_and_b32_dpp v34, v58, v60 quad_perm:[3,3,3,3] row_mask:0xf bank_mask:0xf
v_and_b32_dpp v35, v58, v61 quad_perm:[3,3,3,3] row_mask:0xf bank_mask:0xf
v_and_b32_dpp v36, v59, v60 quad_perm:[3,3,3,3] row_mask:0xf bank_mask:0xf
v_and_b32_dpp v37, v59, v61 quad_perm:[3,3,3,3] row_mask:0xf bank_mask:0xf
s_waitcnt vmcnt(28)
s_nop 0
v_mfma_f32_16x16x16_bf16 v[48:51], v[30:31], v[112:113], v[48:51]
v_mfma_f32_16x16x16_bf16 v[52:55], v[30:31], v[114:115], v[52:55]
v_mfma_f32_16x16x16_bf16 v[48:51], v[32:33], v[116:117], v[48:51]
v_mfma_f32_16x16x16_bf16 v[52:55], v[32:33], v[118:119], v[52:55]
v_mfma_f32_16x16x16_bf16 v[48:51], v[34:35], v[120:121], v[48:51]
v_mfma_f32_16x16x16_bf16 v[52:55], v[34:35], v[122:123], v[52:55]
v_mfma_f32_16x16x16_bf16 v[48:51], v[36:37], v[124:125], v[48:51]
v_mfma_f32_16x16x16_bf16 v[52:55], v[36:37], v[126:127], v[52:55]
s_add_u32 s45, s44, 0x4c000
buffer_load_dwordx4 v[240:243], v2, s[40:43], s45 offen offset:0 nt
buffer_load_dwordx4 v[244:247], v2, s[40:43], s45 offen offset:1024 nt
buffer_load_dwordx4 v[248:251], v2, s[40:43], s45 offen offset:2048 nt
buffer_load_dwordx4 v[252:255], v2, s[40:43], s45 offen offset:3072 nt
v_cvt_pk_bf16_f32 v62, v24, v25
v_cvt_pk_bf16_f32 v63, v26, v27
v_cndmask_b32 v28, v28, v62, s[54:55]
v_cndmask_b32 v29, v29, v63, s[54:55]
v_lshlrev_b32 v38, 16, v28
v_and_b32 v39, 0xffff0000, v28
v_lshlrev_b32 v40, 16, v29
v_and_b32 v41, 0xffff0000, v29
v_mul_f32 v38, s56, v38
v_mul_f32 v39, s56, v39
v_mul_f32 v40, s56, v40
v_mul_f32 v41, s56, v41
v_cvt_pk_bf16_f32 v42, v38, v39
v_lshlrev_b32 v38, 16, v42
v_and_b32 v39, 0xffff0000, v42
v_cvt_pk_bf16_f32 v43, v40, v41
v_lshlrev_b32 v40, 16, v43
v_and_b32 v41, 0xffff0000, v43
v_max3_f32 v42, v38, v39, v40
v_max_f32 v42, v42, v41
v_cmp_gt_f32 vcc, v42, v46
s_cbranch_vccz L_grp_4
s_nop 1
v_max_f32_dpp v42, v42, v42 quad_perm:[1,0,3,2] row_mask:0xf bank_mask:0xf
s_nop 1
v_max_f32_dpp v42, v42, v42 quad_perm:[2,3,0,1] row_mask:0xf bank_mask:0xf
v_mov_b32 v43, v42
s_nop 1
v_permlane16_swap_b32 v42, v43
s_nop 1
v_max_f32 v42, v42, v43
v_mov_b32 v43, v42
s_nop 1
v_permlane32_swap_b32 v42, v43
s_nop 1
v_max_f32 v42, v42, v43
v_max_f32 v42, v42, v46
v_sub_f32 v43, v46, v42
v_mul_f32 v43, s57, v43
v_exp_f32 v43, v43
v_mov_b32 v46, v42
v_mul_f32 v3, s57, v42
v_sub_f32 v3, 0, v3
v_mul_f32 v47, v47, v43
v_mov_b32_dpp v44, v43 row_newbcast:0 row_mask:0x1 bank_mask:0xf
v_mov_b32_dpp v44, v43 row_newbcast:4 row_mask:0x2 bank_mask:0xf
v_mov_b32_dpp v44, v43 row_newbcast:8 row_mask:0x4 bank_mask:0xf
v_mov_b32_dpp v44, v43 row_newbcast:12 row_mask:0x8 bank_mask:0xf
v_mul_f32 v48, v48, v44
v_mul_f32 v49, v49, v44
v_mul_f32 v50, v50, v44
v_mul_f32 v51, v51, v44
v_mul_f32 v52, v52, v44
v_mul_f32 v53, v53, v44
v_mul_f32 v54, v54, v44
v_mul_f32 v55, v55, v44
L_grp_4:
v_fma_f32 v38, v38, s57, v3
v_fma_f32 v39, v39, s57, v3
v_fma_f32 v40, v40, s57, v3
v_fma_f32 v41, v41, s57, v3
v_exp_f32 v38, v38
v_exp_f32 v39, v39
v_exp_f32 v40, v40
v_exp_f32 v41, v41
s_nop 0
v_cvt_pk_bf16_f32 v56, v38, v38
v_cvt_pk_bf16_f32 v57, v39, v39
v_cvt_pk_bf16_f32 v58, v40, v40
v_cvt_pk_bf16_f32 v59, v41, v41
v_add_f32 v38, v38, v39
v_add_f32 v40, v40, v41
v_add_f32 v47, v47, v38
v_add_f32 v47, v47, v40
s_waitcnt vmcnt(28)
v_mfma_f32_16x16x32_bf16 v[20:23], v[128:131], v[4:7], 0
v_mfma_f32_16x16x32_bf16 v[20:23], v[132:135], v[8:11], v[20:23]
v_mfma_f32_16x16x32_bf16 v[20:23], v[136:139], v[12:15], v[20:23]
v_mfma_f32_16x16x32_bf16 v[20:23], v[140:143], v[16:19], v[20:23]
s_add_u32 s45, s44, 0x60000
buffer_load_dwordx4 v[64:67], v1, s[36:39], s45 offen offset:0 nt
buffer_load_dwordx4 v[68:71], v1, s[36:39], s45 offen offset:64 nt
buffer_load_dwordx4 v[72:75], v1, s[36:39], s45 offen offset:128 nt
buffer_load_dwordx4 v[76:79], v1, s[36:39], s45 offen offset:192 nt
v_and_b32_dpp v30, v56, v60 quad_perm:[0,0,0,0] row_mask:0xf bank_mask:0xf
v_and_b32_dpp v31, v56, v61 quad_perm:[0,0,0,0] row_mask:0xf bank_mask:0xf
v_and_b32_dpp v32, v57, v60 quad_perm:[0,0,0,0] row_mask:0xf bank_mask:0xf
v_and_b32_dpp v33, v57, v61 quad_perm:[0,0,0,0] row_mask:0xf bank_mask:0xf
v_and_b32_dpp v34, v58, v60 quad_perm:[0,0,0,0] row_mask:0xf bank_mask:0xf
v_and_b32_dpp v35, v58, v61 quad_perm:[0,0,0,0] row_mask:0xf bank_mask:0xf
v_and_b32_dpp v36, v59, v60 quad_perm:[0,0,0,0] row_mask:0xf bank_mask:0xf
v_and_b32_dpp v37, v59, v61 quad_perm:[0,0,0,0] row_mask:0xf bank_mask:0xf
s_waitcnt vmcnt(28)
s_nop 0
v_mfma_f32_16x16x16_bf16 v[48:51], v[30:31], v[144:145], v[48:51]
v_mfma_f32_16x16x16_bf16 v[52:55], v[30:31], v[146:147], v[52:55]
v_mfma_f32_16x16x16_bf16 v[48:51], v[32:33], v[148:149], v[48:51]
v_mfma_f32_16x16x16_bf16 v[52:55], v[32:33], v[150:151], v[52:55]
v_mfma_f32_16x16x16_bf16 v[48:51], v[34:35], v[152:153], v[48:51]
v_mfma_f32_16x16x16_bf16 v[52:55], v[34:35], v[154:155], v[52:55]
v_mfma_f32_16x16x16_bf16 v[48:51], v[36:37], v[156:157], v[48:51]
v_mfma_f32_16x16x16_bf16 v[52:55], v[36:37], v[158:159], v[52:55]
s_add_u32 s45, s44, 0x50000
buffer_load_dwordx4 v[80:83], v2, s[40:43], s45 offen offset:0 nt
buffer_load_dwordx4 v[84:87], v2, s[40:43], s45 offen offset:1024 nt
buffer_load_dwordx4 v[88:91], v2, s[40:43], s45 offen offset:2048 nt
buffer_load_dwordx4 v[92:95], v2, s[40:43], s45 offen offset:3072 nt
v_cvt_pk_bf16_f32 v28, v20, v21
v_cvt_pk_bf16_f32 v29, v22, v23
s_waitcnt vmcnt(28)
v_mfma_f32_16x16x32_bf16 v[24:27], v[160:163], v[4:7], 0
v_mfma_f32_16x16x32_bf16 v[24:27], v[164:167], v[8:11], v[24:27]
v_mfma_f32_16x16x32_bf16 v[24:27], v[168:171], v[12:15], v[24:27]
v_mfma_f32_16x16x32_bf16 v[24:27], v[172:175], v[16:19], v[24:27]
s_add_u32 s45, s44, 0x64000
buffer_load_dwordx4 v[96:99], v1, s[36:39], s45 offen offset:0 nt
buffer_load_dwordx4 v[100:103], v1, s[36:39], s45 offen offset:64 nt
buffer_load_dwordx4 v[104:107], v1, s[36:39], s45 offen offset:128 nt
buffer_load_dwordx4 v[108:111], v1, s[36:39], s45 offen offset:192 nt
v_and_b32_dpp v30, v56, v60 quad_perm:[1,1,1,1] row_mask:0xf bank_mask:0xf
v_and_b32_dpp v31, v56, v61 quad_perm:[1,1,1,1] row_mask:0xf bank_mask:0xf
v_and_b32_dpp v32, v57, v60 quad_perm:[1,1,1,1] row_mask:0xf bank_mask:0xf
v_and_b32_dpp v33, v57, v61 quad_perm:[1,1,1,1] row_mask:0xf bank_mask:0xf
v_and_b32_dpp v34, v58, v60 quad_perm:[1,1,1,1] row_mask:0xf bank_mask:0xf
v_and_b32_dpp v35, v58, v61 quad_perm:[1,1,1,1] row_mask:0xf bank_mask:0xf
v_and_b32_dpp v36, v59, v60 quad_perm:[1,1,1,1] row_mask:0xf bank_mask:0xf
v_and_b32_dpp v37, v59, v61 quad_perm:[1,1,1,1] row_mask:0xf bank_mask:0xf
s_waitcnt vmcnt(28)
s_nop 0
v_mfma_f32_16x16x16_bf16 v[48:51], v[30:31], v[176:177], v[48:51]
v_mfma_f32_16x16x16_bf16 v[52:55], v[30:31], v[178:179], v[52:55]
v_mfma_f32_16x16x16_bf16 v[48:51], v[32:33], v[180:181], v[48:51]
v_mfma_f32_16x16x16_bf16 v[52:55], v[32:33], v[182:183], v[52:55]
v_mfma_f32_16x16x16_bf16 v[48:51], v[34:35], v[184:185], v[48:51]
v_mfma_f32_16x16x16_bf16 v[52:55], v[34:35], v[186:187], v[52:55]
v_mfma_f32_16x16x16_bf16 v[48:51], v[36:37], v[188:189], v[48:51]
v_mfma_f32_16x16x16_bf16 v[52:55], v[36:37], v[190:191], v[52:55]
s_add_u32 s45, s44, 0x54000
buffer_load_dwordx4 v[112:115], v2, s[40:43], s45 offen offset:0 nt
buffer_load_dwordx4 v[116:119], v2, s[40:43], s45 offen offset:1024 nt
buffer_load_dwordx4 v[120:123], v2, s[40:43], s45 offen offset:2048 nt
buffer_load_dwordx4 v[124:127], v2, s[40:43], s45 offen offset:3072 nt
v_cvt_pk_bf16_f32 v62, v24, v25
v_cvt_pk_bf16_f32 v63, v26, v27
v_cndmask_b32 v28, v28, v62, s[50:51]
v_cndmask_b32 v29, v29, v63, s[50:51]
s_waitcnt vmcnt(28)
v_mfma_f32_16x16x32_bf16 v[20:23], v[192:195], v[4:7], 0
v_mfma_f32_16x16x32_bf16 v[20:23], v[196:199], v[8:11], v[20:23]
v_mfma_f32_16x16x32_bf16 v[20:23], v[200:203], v[12:15], v[20:23]
v_mfma_f32_16x16x32_bf16 v[20:23], v[204:207], v[16:19], v[20:23]
s_add_u32 s45, s44, 0x68000
buffer_load_dwordx4 v[128:131], v1, s[36:39], s45 offen offset:0 nt
buffer_load_dwordx4 v[132:135], v1, s[36:39], s45 offen offset:64 nt
buffer_load_dwordx4 v[136:139], v1, s[36:39], s45 offen offset:128 nt
buffer_load_dwordx4 v[140:143], v1, s[36:39], s45 offen offset:192 nt
v_and_b32_dpp v30, v56, v60 quad_perm:[2,2,2,2] row_mask:0xf bank_mask:0xf
v_and_b32_dpp v31, v56, v61 quad_perm:[2,2,2,2] row_mask:0xf bank_mask:0xf
v_and_b32_dpp v32, v57, v60 quad_perm:[2,2,2,2] row_mask:0xf bank_mask:0xf
v_and_b32_dpp v33, v57, v61 quad_perm:[2,2,2,2] row_mask:0xf bank_mask:0xf
v_and_b32_dpp v34, v58, v60 quad_perm:[2,2,2,2] row_mask:0xf bank_mask:0xf
v_and_b32_dpp v35, v58, v61 quad_perm:[2,2,2,2] row_mask:0xf bank_mask:0xf
v_and_b32_dpp v36, v59, v60 quad_perm:[2,2,2,2] row_mask:0xf bank_mask:0xf
v_and_b32_dpp v37, v59, v61 quad_perm:[2,2,2,2] row_mask:0xf bank_mask:0xf
s_waitcnt vmcnt(28)
s_nop 0
v_mfma_f32_16x16x16_bf16 v[48:51], v[30:31], v[208:209], v[48:51]
v_mfma_f32_16x16x16_bf16 v[52:55], v[30:31], v[210:211], v[52:55]
v_mfma_f32_16x16x16_bf16 v[48:51], v[32:33], v[212:213], v[48:51]
v_mfma_f32_16x16x16_bf16 v[52:55], v[32:33], v[214:215], v[52:55]
v_mfma_f32_16x16x16_bf16 v[48:51], v[34:35], v[216:217], v[48:51]
v_mfma_f32_16x16x16_bf16 v[52:55], v[34:35], v[218:219], v[52:55]
v_mfma_f32_16x16x16_bf16 v[48:51], v[36:37], v[220:221], v[48:51]
v_mfma_f32_16x16x16_bf16 v[52:55], v[36:37], v[222:223], v[52:55]
s_add_u32 s45, s44, 0x58000
buffer_load_dwordx4 v[144:147], v2, s[40:43], s45 offen offset:0 nt
buffer_load_dwordx4 v[148:151], v2, s[40:43], s45 offen offset:1024 nt
buffer_load_dwordx4 v[152:155], v2, s[40:43], s45 offen offset:2048 nt
buffer_load_dwordx4 v[156:159], v2, s[40:43], s45 offen offset:3072 nt
v_cvt_pk_bf16_f32 v62, v20, v21
v_cvt_pk_bf16_f32 v63, v22, v23
v_cndmask_b32 v28, v28, v62, s[52:53]
v_cndmask_b32 v29, v29, v63, s[52:53]
s_waitcnt vmcnt(28)
v_mfma_f32_16x16x32_bf16 v[24:27], v[224:227], v[4:7], 0
v_mfma_f32_16x16x32_bf16 v[24:27], v[228:231], v[8:11], v[24:27]
v_mfma_f32_16x16x32_bf16 v[24:27], v[232:235], v[12:15], v[24:27]
v_mfma_f32_16x16x32_bf16 v[24:27], v[236:239], v[16:19], v[24:27]
s_add_u32 s45, s44, 0x6c000
buffer_load_dwordx4 v[160:163], v1, s[36:39], s45 offen offset:0 nt
buffer_load_dwordx4 v[164:167], v1, s[36:39], s45 offen offset:64 nt
buffer_load_dwordx4 v[168:171], v1, s[36:39], s45 offen offset:128 nt
buffer_load_dwordx4 v[172:175], v1, s[36:39], s45 offen offset:192 nt
v_and_b32_dpp v30, v56, v60 quad_perm:[3,3,3,3] row_mask:0xf bank_mask:0xf
v_and_b32_dpp v31, v56, v61 quad_perm:[3,3,3,3] row_mask:0xf bank_mask:0xf
v_and_b32_dpp v32, v57, v60 quad_perm:[3,3,3,3] row_mask:0xf bank_mask:0xf
v_and_b32_dpp v33, v57, v61 quad_perm:[3,3,3,3] row_mask:0xf bank_mask:0xf
v_and_b32_dpp v34, v58, v60 quad_perm:[3,3,3,3] row_mask:0xf bank_mask:0xf
v_and_b32_dpp v35, v58, v61 quad_perm:[3,3,3,3] row_mask:0xf bank_mask:0xf
v_and_b32_dpp v36, v59, v60 quad_perm:[3,3,3,3] row_mask:0xf bank_mask:0xf
v_and_b32_dpp v37, v59, v61 quad_perm:[3,3,3,3] row_mask:0xf bank_mask:0xf
s_waitcnt vmcnt(28)
s_nop 0
v_mfma_f32_16x16x16_bf16 v[48:51], v[30:31], v[240:241], v[48:51]
v_mfma_f32_16x16x16_bf16 v[52:55], v[30:31], v[242:243], v[52:55]
v_mfma_f32_16x16x16_bf16 v[48:51], v[32:33], v[244:245], v[48:51]
v_mfma_f32_16x16x16_bf16 v[52:55], v[32:33], v[246:247], v[52:55]
v_mfma_f32_16x16x16_bf16 v[48:51], v[34:35], v[248:249], v[48:51]
v_mfma_f32_16x16x16_bf16 v[52:55], v[34:35], v[250:251], v[52:55]
v_mfma_f32_16x16x16_bf16 v[48:51], v[36:37], v[252:253], v[48:51]
v_mfma_f32_16x16x16_bf16 v[52:55], v[36:37], v[254:255], v[52:55]
s_add_u32 s45, s44, 0x5c000
buffer_load_dwordx4 v[176:179], v2, s[40:43], s45 offen offset:0 nt
buffer_load_dwordx4 v[180:183], v2, s[40:43], s45 offen offset:1024 nt
buffer_load_dwordx4 v[184:187], v2, s[40:43], s45 offen offset:2048 nt
buffer_load_dwordx4 v[188:191], v2, s[40:43], s45 offen offset:3072 nt
v_cvt_pk_bf16_f32 v62, v24, v25
v_cvt_pk_bf16_f32 v63, v26, v27
v_cndmask_b32 v28, v28, v62, s[54:55]
v_cndmask_b32 v29, v29, v63, s[54:55]
v_lshlrev_b32 v38, 16, v28
v_and_b32 v39, 0xffff0000, v28
v_lshlrev_b32 v40, 16, v29
v_and_b32 v41, 0xffff0000, v29
v_mul_f32 v38, s56, v38
v_mul_f32 v39, s56, v39
v_mul_f32 v40, s56, v40
v_mul_f32 v41, s56, v41
v_cvt_pk_bf16_f32 v42, v38, v39
v_lshlrev_b32 v38, 16, v42
v_and_b32 v39, 0xffff0000, v42
v_cvt_pk_bf16_f32 v43, v40, v41
v_lshlrev_b32 v40, 16, v43
v_and_b32 v41, 0xffff0000, v43
v_max3_f32 v42, v38, v39, v40
v_max_f32 v42, v42, v41
v_cmp_gt_f32 vcc, v42, v46
s_cbranch_vccz L_grp_5
s_nop 1
v_max_f32_dpp v42, v42, v42 quad_perm:[1,0,3,2] row_mask:0xf bank_mask:0xf
s_nop 1
v_max_f32_dpp v42, v42, v42 quad_perm:[2,3,0,1] row_mask:0xf bank_mask:0xf
v_mov_b32 v43, v42
s_nop 1
v_permlane16_swap_b32 v42, v43
s_nop 1
v_max_f32 v42, v42, v43
v_mov_b32 v43, v42
s_nop 1
v_permlane32_swap_b32 v42, v43
s_nop 1
v_max_f32 v42, v42, v43
v_max_f32 v42, v42, v46
v_sub_f32 v43, v46, v42
v_mul_f32 v43, s57, v43
v_exp_f32 v43, v43
v_mov_b32 v46, v42
v_mul_f32 v3, s57, v42
v_sub_f32 v3, 0, v3
v_mul_f32 v47, v47, v43
v_mov_b32_dpp v44, v43 row_newbcast:0 row_mask:0x1 bank_mask:0xf
v_mov_b32_dpp v44, v43 row_newbcast:4 row_mask:0x2 bank_mask:0xf
v_mov_b32_dpp v44, v43 row_newbcast:8 row_mask:0x4 bank_mask:0xf
v_mov_b32_dpp v44, v43 row_newbcast:12 row_mask:0x8 bank_mask:0xf
v_mul_f32 v48, v48, v44
v_mul_f32 v49, v49, v44
v_mul_f32 v50, v50, v44
v_mul_f32 v51, v51, v44
v_mul_f32 v52, v52, v44
v_mul_f32 v53, v53, v44
v_mul_f32 v54, v54, v44
v_mul_f32 v55, v55, v44
L_grp_5:
v_fma_f32 v38, v38, s57, v3
v_fma_f32 v39, v39, s57, v3
v_fma_f32 v40, v40, s57, v3
v_fma_f32 v41, v41, s57, v3
v_exp_f32 v38, v38
v_exp_f32 v39, v39
v_exp_f32 v40, v40
v_exp_f32 v41, v41
s_nop 0
v_cvt_pk_bf16_f32 v56, v38, v38
v_cvt_pk_bf16_f32 v57, v39, v39
v_cvt_pk_bf16_f32 v58, v40, v40
v_cvt_pk_bf16_f32 v59, v41, v41
v_add_f32 v38, v38, v39
v_add_f32 v40, v40, v41
v_add_f32 v47, v47, v38
v_add_f32 v47, v47, v40
s_waitcnt vmcnt(28)
v_mfma_f32_16x16x32_bf16 v[20:23], v[64:67], v[4:7], 0
v_mfma_f32_16x16x32_bf16 v[20:23], v[68:71], v[8:11], v[20:23]
v_mfma_f32_16x16x32_bf16 v[20:23], v[72:75], v[12:15], v[20:23]
v_mfma_f32_16x16x32_bf16 v[20:23], v[76:79], v[16:19], v[20:23]
s_add_u32 s45, s44, 0x70000
buffer_load_dwordx4 v[192:195], v1, s[36:39], s45 offen offset:0 nt
buffer_load_dwordx4 v[196:199], v1, s[36:39], s45 offen offset:64 nt
buffer_load_dwordx4 v[200:203], v1, s[36:39], s45 offen offset:128 nt
buffer_load_dwordx4 v[204:207], v1, s[36:39], s45 offen offset:192 nt
v_and_b32_dpp v30, v56, v60 quad_perm:[0,0,0,0] row_mask:0xf bank_mask:0xf
v_and_b32_dpp v31, v56, v61 quad_perm:[0,0,0,0] row_mask:0xf bank_mask:0xf
v_and_b32_dpp v32, v57, v60 quad_perm:[0,0,0,0] row_mask:0xf bank_mask:0xf
v_and_b32_dpp v33, v57, v61 quad_perm:[0,0,0,0] row_mask:0xf bank_mask:0xf
v_and_b32_dpp v34, v58, v60 quad_perm:[0,0,0,0] row_mask:0xf bank_mask:0xf
v_and_b32_dpp v35, v58, v61 quad_perm:[0,0,0,0] row_mask:0xf bank_mask:0xf
v_and_b32_dpp v36, v59, v60 quad_perm:[0,0,0,0] row_mask:0xf bank_mask:0xf
v_and_b32_dpp v37, v59, v61 quad_perm:[0,0,0,0] row_mask:0xf bank_mask:0xf
s_waitcnt vmcnt(28)
s_nop 0
v_mfma_f32_16x16x16_bf16 v[48:51], v[30:31], v[80:81], v[48:51]
v_mfma_f32_16x16x16_bf16 v[52:55], v[30:31], v[82:83], v[52:55]
v_mfma_f32_16x16x16_bf16 v[48:51], v[32:33], v[84:85], v[48:51]
v_mfma_f32_16x16x16_bf16 v[52:55], v[32:33], v[86:87], v[52:55]
v_mfma_f32_16x16x16_bf16 v[48:51], v[34:35], v[88:89], v[48:51]
v_mfma_f32_16x16x16_bf16 v[52:55], v[34:35], v[90:91], v[52:55]
v_mfma_f32_16x16x16_bf16 v[48:51], v[36:37], v[92:93], v[48:51]
v_mfma_f32_16x16x16_bf16 v[52:55], v[36:37], v[94:95], v[52:55]
s_add_u32 s45, s44, 0x60000
buffer_load_dwordx4 v[208:211], v2, s[40:43], s45 offen offset:0 nt
buffer_load_dwordx4 v[212:215], v2, s[40:43], s45 offen offset:1024 nt
buffer_load_dwordx4 v[216:219], v2, s[40:43], s45 offen offset:2048 nt
buffer_load_dwordx4 v[220:223], v2, s[40:43], s45 offen offset:3072 nt
v_cvt_pk_bf16_f32 v28, v20, v21
v_cvt_pk_bf16_f32 v29, v22, v23
s_waitcnt vmcnt(28)
v_mfma_f32_16x16x32_bf16 v[24:27], v[96:99], v[4:7], 0
v_mfma_f32_16x16x32_bf16 v[24:27], v[100:103], v[8:11], v[24:27]
v_mfma_f32_16x16x32_bf16 v[24:27], v[104:107], v[12:15], v[24:27]
v_mfma_f32_16x16x32_bf16 v[24:27], v[108:111], v[16:19], v[24:27]
s_add_u32 s45, s44, 0x74000
buffer_load_dwordx4 v[224:227], v1, s[36:39], s45 offen offset:0 nt
buffer_load_dwordx4 v[228:231], v1, s[36:39], s45 offen offset:64 nt
buffer_load_dwordx4 v[232:235], v1, s[36:39], s45 offen offset:128 nt
buffer_load_dwordx4 v[236:239], v1, s[36:39], s45 offen offset:192 nt
v_and_b32_dpp v30, v56, v60 quad_perm:[1,1,1,1] row_mask:0xf bank_mask:0xf
v_and_b32_dpp v31, v56, v61 quad_perm:[1,1,1,1] row_mask:0xf bank_mask:0xf
v_and_b32_dpp v32, v57, v60 quad_perm:[1,1,1,1] row_mask:0xf bank_mask:0xf
v_and_b32_dpp v33, v57, v61 quad_perm:[1,1,1,1] row_mask:0xf bank_mask:0xf
v_and_b32_dpp v34, v58, v60 quad_perm:[1,1,1,1] row_mask:0xf bank_mask:0xf
v_and_b32_dpp v35, v58, v61 quad_perm:[1,1,1,1] row_mask:0xf bank_mask:0xf
v_and_b32_dpp v36, v59, v60 quad_perm:[1,1,1,1] row_mask:0xf bank_mask:0xf
v_and_b32_dpp v37, v59, v61 quad_perm:[1,1,1,1] row_mask:0xf bank_mask:0xf
s_waitcnt vmcnt(28)
s_nop 0
v_mfma_f32_16x16x16_bf16 v[48:51], v[30:31], v[112:113], v[48:51]
v_mfma_f32_16x16x16_bf16 v[52:55], v[30:31], v[114:115], v[52:55]
v_mfma_f32_16x16x16_bf16 v[48:51], v[32:33], v[116:117], v[48:51]
v_mfma_f32_16x16x16_bf16 v[52:55], v[32:33], v[118:119], v[52:55]
v_mfma_f32_16x16x16_bf16 v[48:51], v[34:35], v[120:121], v[48:51]
v_mfma_f32_16x16x16_bf16 v[52:55], v[34:35], v[122:123], v[52:55]
v_mfma_f32_16x16x16_bf16 v[48:51], v[36:37], v[124:125], v[48:51]
v_mfma_f32_16x16x16_bf16 v[52:55], v[36:37], v[126:127], v[52:55]
s_add_u32 s45, s44, 0x64000
buffer_load_dwordx4 v[240:243], v2, s[40:43], s45 offen offset:0 nt
buffer_load_dwordx4 v[244:247], v2, s[40:43], s45 offen offset:1024 nt
buffer_load_dwordx4 v[248:251], v2, s[40:43], s45 offen offset:2048 nt
buffer_load_dwordx4 v[252:255], v2, s[40:43], s45 offen offset:3072 nt
v_cvt_pk_bf16_f32 v62, v24, v25
v_cvt_pk_bf16_f32 v63, v26, v27
v_cndmask_b32 v28, v28, v62, s[50:51]
v_cndmask_b32 v29, v29, v63, s[50:51]
s_waitcnt vmcnt(28)
v_mfma_f32_16x16x32_bf16 v[20:23], v[128:131], v[4:7], 0
v_mfma_f32_16x16x32_bf16 v[20:23], v[132:135], v[8:11], v[20:23]
v_mfma_f32_16x16x32_bf16 v[20:23], v[136:139], v[12:15], v[20:23]
v_mfma_f32_16x16x32_bf16 v[20:23], v[140:143], v[16:19], v[20:23]
s_add_u32 s45, s44, 0x78000
buffer_load_dwordx4 v[64:67], v1, s[36:39], s45 offen offset:0 nt
buffer_load_dwordx4 v[68:71], v1, s[36:39], s45 offen offset:64 nt
buffer_load_dwordx4 v[72:75], v1, s[36:39], s45 offen offset:128 nt
buffer_load_dwordx4 v[76:79], v1, s[36:39], s45 offen offset:192 nt
v_and_b32_dpp v30, v56, v60 quad_perm:[2,2,2,2] row_mask:0xf bank_mask:0xf
v_and_b32_dpp v31, v56, v61 quad_perm:[2,2,2,2] row_mask:0xf bank_mask:0xf
v_and_b32_dpp v32, v57, v60 quad_perm:[2,2,2,2] row_mask:0xf bank_mask:0xf
v_and_b32_dpp v33, v57, v61 quad_perm:[2,2,2,2] row_mask:0xf bank_mask:0xf
v_and_b32_dpp v34, v58, v60 quad_perm:[2,2,2,2] row_mask:0xf bank_mask:0xf
v_and_b32_dpp v35, v58, v61 quad_perm:[2,2,2,2] row_mask:0xf bank_mask:0xf
v_and_b32_dpp v36, v59, v60 quad_perm:[2,2,2,2] row_mask:0xf bank_mask:0xf
v_and_b32_dpp v37, v59, v61 quad_perm:[2,2,2,2] row_mask:0xf bank_mask:0xf
s_waitcnt vmcnt(28)
s_nop 0
v_mfma_f32_16x16x16_bf16 v[48:51], v[30:31], v[144:145], v[48:51]
v_mfma_f32_16x16x16_bf16 v[52:55], v[30:31], v[146:147], v[52:55]
v_mfma_f32_16x16x16_bf16 v[48:51], v[32:33], v[148:149], v[48:51]
v_mfma_f32_16x16x16_bf16 v[52:55], v[32:33], v[150:151], v[52:55]
v_mfma_f32_16x16x16_bf16 v[48:51], v[34:35], v[152:153], v[48:51]
v_mfma_f32_16x16x16_bf16 v[52:55], v[34:35], v[154:155], v[52:55]
v_mfma_f32_16x16x16_bf16 v[48:51], v[36:37], v[156:157], v[48:51]
v_mfma_f32_16x16x16_bf16 v[52:55], v[36:37], v[158:159], v[52:55]
s_add_u32 s45, s44, 0x68000
buffer_load_dwordx4 v[80:83], v2, s[40:43], s45 offen offset:0 nt
buffer_load_dwordx4 v[84:87], v2, s[40:43], s45 offen offset:1024 nt
buffer_load_dwordx4 v[88:91], v2, s[40:43], s45 offen offset:2048 nt
buffer_load_dwordx4 v[92:95], v2, s[40:43], s45 offen offset:3072 nt
v_cvt_pk_bf16_f32 v62, v20, v21
v_cvt_pk_bf16_f32 v63, v22, v23
v_cndmask_b32 v28, v28, v62, s[52:53]
v_cndmask_b32 v29, v29, v63, s[52:53]
s_waitcnt vmcnt(28)
v_mfma_f32_16x16x32_bf16 v[24:27], v[160:163], v[4:7], 0
v_mfma_f32_16x16x32_bf16 v[24:27], v[164:167], v[8:11], v[24:27]
v_mfma_f32_16x16x32_bf16 v[24:27], v[168:171], v[12:15], v[24:27]
v_mfma_f32_16x16x32_bf16 v[24:27], v[172:175], v[16:19], v[24:27]
s_add_u32 s45, s44, 0x7c000
buffer_load_dwordx4 v[96:99], v1, s[36:39], s45 offen offset:0 nt
buffer_load_dwordx4 v[100:103], v1, s[36:39], s45 offen offset:64 nt
buffer_load_dwordx4 v[104:107], v1, s[36:39], s45 offen offset:128 nt
buffer_load_dwordx4 v[108:111], v1, s[36:39], s45 offen offset:192 nt
v_and_b32_dpp v30, v56, v60 quad_perm:[3,3,3,3] row_mask:0xf bank_mask:0xf
v_and_b32_dpp v31, v56, v61 quad_perm:[3,3,3,3] row_mask:0xf bank_mask:0xf
v_and_b32_dpp v32, v57, v60 quad_perm:[3,3,3,3] row_mask:0xf bank_mask:0xf
v_and_b32_dpp v33, v57, v61 quad_perm:[3,3,3,3] row_mask:0xf bank_mask:0xf
v_and_b32_dpp v34, v58, v60 quad_perm:[3,3,3,3] row_mask:0xf bank_mask:0xf
v_and_b32_dpp v35, v58, v61 quad_perm:[3,3,3,3] row_mask:0xf bank_mask:0xf
v_and_b32_dpp v36, v59, v60 quad_perm:[3,3,3,3] row_mask:0xf bank_mask:0xf
v_and_b32_dpp v37, v59, v61 quad_perm:[3,3,3,3] row_mask:0xf bank_mask:0xf
s_waitcnt vmcnt(28)
s_nop 0
v_mfma_f32_16x16x16_bf16 v[48:51], v[30:31], v[176:177], v[48:51]
v_mfma_f32_16x16x16_bf16 v[52:55], v[30:31], v[178:179], v[52:55]
v_mfma_f32_16x16x16_bf16 v[48:51], v[32:33], v[180:181], v[48:51]
v_mfma_f32_16x16x16_bf16 v[52:55], v[32:33], v[182:183], v[52:55]
v_mfma_f32_16x16x16_bf16 v[48:51], v[34:35], v[184:185], v[48:51]
v_mfma_f32_16x16x16_bf16 v[52:55], v[34:35], v[186:187], v[52:55]
v_mfma_f32_16x16x16_bf16 v[48:51], v[36:37], v[188:189], v[48:51]
v_mfma_f32_16x16x16_bf16 v[52:55], v[36:37], v[190:191], v[52:55]
s_add_u32 s45, s44, 0x6c000
buffer_load_dwordx4 v[112:115], v2, s[40:43], s45 offen offset:0 nt
buffer_load_dwordx4 v[116:119], v2, s[40:43], s45 offen offset:1024 nt
buffer_load_dwordx4 v[120:123], v2, s[40:43], s45 offen offset:2048 nt
buffer_load_dwordx4 v[124:127], v2, s[40:43], s45 offen offset:3072 nt
v_cvt_pk_bf16_f32 v62, v24, v25
v_cvt_pk_bf16_f32 v63, v26, v27
v_cndmask_b32 v28, v28, v62, s[54:55]
v_cndmask_b32 v29, v29, v63, s[54:55]
v_lshlrev_b32 v38, 16, v28
v_and_b32 v39, 0xffff0000, v28
v_lshlrev_b32 v40, 16, v29
v_and_b32 v41, 0xffff0000, v29
v_mul_f32 v38, s56, v38
v_mul_f32 v39, s56, v39
v_mul_f32 v40, s56, v40
v_mul_f32 v41, s56, v41
v_cvt_pk_bf16_f32 v42, v38, v39
v_lshlrev_b32 v38, 16, v42
v_and_b32 v39, 0xffff0000, v42
v_cvt_pk_bf16_f32 v43, v40, v41
v_lshlrev_b32 v40, 16, v43
v_and_b32 v41, 0xffff0000, v43
v_max3_f32 v42, v38, v39, v40
v_max_f32 v42, v42, v41
v_cmp_gt_f32 vcc, v42, v46
s_cbranch_vccz L_grp_6
s_nop 1
v_max_f32_dpp v42, v42, v42 quad_perm:[1,0,3,2] row_mask:0xf bank_mask:0xf
s_nop 1
v_max_f32_dpp v42, v42, v42 quad_perm:[2,3,0,1] row_mask:0xf bank_mask:0xf
v_mov_b32 v43, v42
s_nop 1
v_permlane16_swap_b32 v42, v43
s_nop 1
v_max_f32 v42, v42, v43
v_mov_b32 v43, v42
s_nop 1
v_permlane32_swap_b32 v42, v43
s_nop 1
v_max_f32 v42, v42, v43
v_max_f32 v42, v42, v46
v_sub_f32 v43, v46, v42
v_mul_f32 v43, s57, v43
v_exp_f32 v43, v43
v_mov_b32 v46, v42
v_mul_f32 v3, s57, v42
v_sub_f32 v3, 0, v3
v_mul_f32 v47, v47, v43
v_mov_b32_dpp v44, v43 row_newbcast:0 row_mask:0x1 bank_mask:0xf
v_mov_b32_dpp v44, v43 row_newbcast:4 row_mask:0x2 bank_mask:0xf
v_mov_b32_dpp v44, v43 row_newbcast:8 row_mask:0x4 bank_mask:0xf
v_mov_b32_dpp v44, v43 row_newbcast:12 row_mask:0x8 bank_mask:0xf
v_mul_f32 v48, v48, v44
v_mul_f32 v49, v49, v44
v_mul_f32 v50, v50, v44
v_mul_f32 v51, v51, v44
v_mul_f32 v52, v52, v44
v_mul_f32 v53, v53, v44
v_mul_f32 v54, v54, v44
v_mul_f32 v55, v55, v44
L_grp_6:
v_fma_f32 v38, v38, s57, v3
v_fma_f32 v39, v39, s57, v3
v_fma_f32 v40, v40, s57, v3
v_fma_f32 v41, v41, s57, v3
v_exp_f32 v38, v38
v_exp_f32 v39, v39
v_exp_f32 v40, v40
v_exp_f32 v41, v41
s_nop 0
v_cvt_pk_bf16_f32 v56, v38, v38
v_cvt_pk_bf16_f32 v57, v39, v39
v_cvt_pk_bf16_f32 v58, v40, v40
v_cvt_pk_bf16_f32 v59, v41, v41
v_add_f32 v38, v38, v39
v_add_f32 v40, v40, v41
v_add_f32 v47, v47, v38
v_add_f32 v47, v47, v40
s_waitcnt vmcnt(28)
v_mfma_f32_16x16x32_bf16 v[20:23], v[192:195], v[4:7], 0
v_mfma_f32_16x16x32_bf16 v[20:23], v[196:199], v[8:11], v[20:23]
v_mfma_f32_16x16x32_bf16 v[20:23], v[200:203], v[12:15], v[20:23]
v_mfma_f32_16x16x32_bf16 v[20:23], v[204:207], v[16:19], v[20:23]
s_add_u32 s45, s44, 0x70000
buffer_load_dwordx4 v[128:131], v2, s[40:43], s45 offen offset:0 nt
buffer_load_dwordx4 v[132:135], v2, s[40:43], s45 offen offset:1024 nt
buffer_load_dwordx4 v[136:139], v2, s[40:43], s45 offen offset:2048 nt
buffer_load_dwordx4 v[140:143], v2, s[40:43], s45 offen offset:3072 nt
v_and_b32_dpp v30, v56, v60 quad_perm:[0,0,0,0] row_mask:0xf bank_mask:0xf
v_and_b32_dpp v31, v56, v61 quad_perm:[0,0,0,0] row_mask:0xf bank_mask:0xf
v_and_b32_dpp v32, v57, v60 quad_perm:[0,0,0,0] row_mask:0xf bank_mask:0xf
v_and_b32_dpp v33, v57, v61 quad_perm:[0,0,0,0] row_mask:0xf bank_mask:0xf
v_and_b32_dpp v34, v58, v60 quad_perm:[0,0,0,0] row_mask:0xf bank_mask:0xf
v_and_b32_dpp v35, v58, v61 quad_perm:[0,0,0,0] row_mask:0xf bank_mask:0xf
v_and_b32_dpp v36, v59, v60 quad_perm:[0,0,0,0] row_mask:0xf bank_mask:0xf
v_and_b32_dpp v37, v59, v61 quad_perm:[0,0,0,0] row_mask:0xf bank_mask:0xf
s_waitcnt vmcnt(28)
s_nop 0
v_mfma_f32_16x16x16_bf16 v[48:51], v[30:31], v[208:209], v[48:51]
v_mfma_f32_16x16x16_bf16 v[52:55], v[30:31], v[210:211], v[52:55]
v_mfma_f32_16x16x16_bf16 v[48:51], v[32:33], v[212:213], v[48:51]
v_mfma_f32_16x16x16_bf16 v[52:55], v[32:33], v[214:215], v[52:55]
v_mfma_f32_16x16x16_bf16 v[48:51], v[34:35], v[216:217], v[48:51]
v_mfma_f32_16x16x16_bf16 v[52:55], v[34:35], v[218:219], v[52:55]
v_mfma_f32_16x16x16_bf16 v[48:51], v[36:37], v[220:221], v[48:51]
v_mfma_f32_16x16x16_bf16 v[52:55], v[36:37], v[222:223], v[52:55]
s_add_u32 s45, s44, 0x74000
buffer_load_dwordx4 v[144:147], v2, s[40:43], s45 offen offset:0 nt
buffer_load_dwordx4 v[148:151], v2, s[40:43], s45 offen offset:1024 nt
buffer_load_dwordx4 v[152:155], v2, s[40:43], s45 offen offset:2048 nt
buffer_load_dwordx4 v[156:159], v2, s[40:43], s45 offen offset:3072 nt
v_cvt_pk_bf16_f32 v28, v20, v21
v_cvt_pk_bf16_f32 v29, v22, v23
s_waitcnt vmcnt(28)
v_mfma_f32_16x16x32_bf16 v[24:27], v[224:227], v[4:7], 0
v_mfma_f32_16x16x32_bf16 v[24:27], v[228:231], v[8:11], v[24:27]
v_mfma_f32_16x16x32_bf16 v[24:27], v[232:235], v[12:15], v[24:27]
v_mfma_f32_16x16x32_bf16 v[24:27], v[236:239], v[16:19], v[24:27]
s_add_u32 s45, s44, 0x78000
buffer_load_dwordx4 v[160:163], v2, s[40:43], s45 offen offset:0 nt
buffer_load_dwordx4 v[164:167], v2, s[40:43], s45 offen offset:1024 nt
buffer_load_dwordx4 v[168:171], v2, s[40:43], s45 offen offset:2048 nt
buffer_load_dwordx4 v[172:175], v2, s[40:43], s45 offen offset:3072 nt
v_and_b32_dpp v30, v56, v60 quad_perm:[1,1,1,1] row_mask:0xf bank_mask:0xf
v_and_b32_dpp v31, v56, v61 quad_perm:[1,1,1,1] row_mask:0xf bank_mask:0xf
v_and_b32_dpp v32, v57, v60 quad_perm:[1,1,1,1] row_mask:0xf bank_mask:0xf
v_and_b32_dpp v33, v57, v61 quad_perm:[1,1,1,1] row_mask:0xf bank_mask:0xf
v_and_b32_dpp v34, v58, v60 quad_perm:[1,1,1,1] row_mask:0xf bank_mask:0xf
v_and_b32_dpp v35, v58, v61 quad_perm:[1,1,1,1] row_mask:0xf bank_mask:0xf
v_and_b32_dpp v36, v59, v60 quad_perm:[1,1,1,1] row_mask:0xf bank_mask:0xf
v_and_b32_dpp v37, v59, v61 quad_perm:[1,1,1,1] row_mask:0xf bank_mask:0xf
s_waitcnt vmcnt(28)
s_nop 0
v_mfma_f32_16x16x16_bf16 v[48:51], v[30:31], v[240:241], v[48:51]
v_mfma_f32_16x16x16_bf16 v[52:55], v[30:31], v[242:243], v[52:55]
v_mfma_f32_16x16x16_bf16 v[48:51], v[32:33], v[244:245], v[48:51]
v_mfma_f32_16x16x16_bf16 v[52:55], v[32:33], v[246:247], v[52:55]
v_mfma_f32_16x16x16_bf16 v[48:51], v[34:35], v[248:249], v[48:51]
v_mfma_f32_16x16x16_bf16 v[52:55], v[34:35], v[250:251], v[52:55]
v_mfma_f32_16x16x16_bf16 v[48:51], v[36:37], v[252:253], v[48:51]
v_mfma_f32_16x16x16_bf16 v[52:55], v[36:37], v[254:255], v[52:55]
s_add_u32 s45, s44, 0x7c000
buffer_load_dwordx4 v[176:179], v2, s[40:43], s45 offen offset:0 nt
buffer_load_dwordx4 v[180:183], v2, s[40:43], s45 offen offset:1024 nt
buffer_load_dwordx4 v[184:187], v2, s[40:43], s45 offen offset:2048 nt
buffer_load_dwordx4 v[188:191], v2, s[40:43], s45 offen offset:3072 nt
v_cvt_pk_bf16_f32 v62, v24, v25
v_cvt_pk_bf16_f32 v63, v26, v27
v_cndmask_b32 v28, v28, v62, s[50:51]
v_cndmask_b32 v29, v29, v63, s[50:51]
s_waitcnt vmcnt(28)
v_mfma_f32_16x16x32_bf16 v[20:23], v[64:67], v[4:7], 0
v_mfma_f32_16x16x32_bf16 v[20:23], v[68:71], v[8:11], v[20:23]
v_mfma_f32_16x16x32_bf16 v[20:23], v[72:75], v[12:15], v[20:23]
v_mfma_f32_16x16x32_bf16 v[20:23], v[76:79], v[16:19], v[20:23]
s_nop 4
v_and_b32_dpp v30, v56, v60 quad_perm:[2,2,2,2] row_mask:0xf bank_mask:0xf
v_and_b32_dpp v31, v56, v61 quad_perm:[2,2,2,2] row_mask:0xf bank_mask:0xf
v_and_b32_dpp v32, v57, v60 quad_perm:[2,2,2,2] row_mask:0xf bank_mask:0xf
v_and_b32_dpp v33, v57, v61 quad_perm:[2,2,2,2] row_mask:0xf bank_mask:0xf
v_and_b32_dpp v34, v58, v60 quad_perm:[2,2,2,2] row_mask:0xf bank_mask:0xf
v_and_b32_dpp v35, v58, v61 quad_perm:[2,2,2,2] row_mask:0xf bank_mask:0xf
v_and_b32_dpp v36, v59, v60 quad_perm:[2,2,2,2] row_mask:0xf bank_mask:0xf
v_and_b32_dpp v37, v59, v61 quad_perm:[2,2,2,2] row_mask:0xf bank_mask:0xf
s_waitcnt vmcnt(24)
s_nop 0
v_mfma_f32_16x16x16_bf16 v[48:51], v[30:31], v[80:81], v[48:51]
v_mfma_f32_16x16x16_bf16 v[52:55], v[30:31], v[82:83], v[52:55]
v_mfma_f32_16x16x16_bf16 v[48:51], v[32:33], v[84:85], v[48:51]
v_mfma_f32_16x16x16_bf16 v[52:55], v[32:33], v[86:87], v[52:55]
v_mfma_f32_16x16x16_bf16 v[48:51], v[34:35], v[88:89], v[48:51]
v_mfma_f32_16x16x16_bf16 v[52:55], v[34:35], v[90:91], v[52:55]
v_mfma_f32_16x16x16_bf16 v[48:51], v[36:37], v[92:93], v[48:51]
v_mfma_f32_16x16x16_bf16 v[52:55], v[36:37], v[94:95], v[52:55]
v_cvt_pk_bf16_f32 v62, v20, v21
v_cvt_pk_bf16_f32 v63, v22, v23
v_cndmask_b32 v28, v28, v62, s[52:53]
v_cndmask_b32 v29, v29, v63, s[52:53]
s_waitcnt vmcnt(20)
v_mfma_f32_16x16x32_bf16 v[24:27], v[96:99], v[4:7], 0
v_mfma_f32_16x16x32_bf16 v[24:27], v[100:103], v[8:11], v[24:27]
v_mfma_f32_16x16x32_bf16 v[24:27], v[104:107], v[12:15], v[24:27]
v_mfma_f32_16x16x32_bf16 v[24:27], v[108:111], v[16:19], v[24:27]
s_nop 4
v_and_b32_dpp v30, v56, v60 quad_perm:[3,3,3,3] row_mask:0xf bank_mask:0xf
v_and_b32_dpp v31, v56, v61 quad_perm:[3,3,3,3] row_mask:0xf bank_mask:0xf
v_and_b32_dpp v32, v57, v60 quad_perm:[3,3,3,3] row_mask:0xf bank_mask:0xf
v_and_b32_dpp v33, v57, v61 quad_perm:[3,3,3,3] row_mask:0xf bank_mask:0xf
v_and_b32_dpp v34, v58, v60 quad_perm:[3,3,3,3] row_mask:0xf bank_mask:0xf
v_and_b32_dpp v35, v58, v61 quad_perm:[3,3,3,3] row_mask:0xf bank_mask:0xf
v_and_b32_dpp v36, v59, v60 quad_perm:[3,3,3,3] row_mask:0xf bank_mask:0xf
v_and_b32_dpp v37, v59, v61 quad_perm:[3,3,3,3] row_mask:0xf bank_mask:0xf
s_waitcnt vmcnt(16)
s_nop 0
v_mfma_f32_16x16x16_bf16 v[48:51], v[30:31], v[112:113], v[48:51]
v_mfma_f32_16x16x16_bf16 v[52:55], v[30:31], v[114:115], v[52:55]
v_mfma_f32_16x16x16_bf16 v[48:51], v[32:33], v[116:117], v[48:51]
v_mfma_f32_16x16x16_bf16 v[52:55], v[32:33], v[118:119], v[52:55]
v_mfma_f32_16x16x16_bf16 v[48:51], v[34:35], v[120:121], v[48:51]
v_mfma_f32_16x16x16_bf16 v[52:55], v[34:35], v[122:123], v[52:55]
v_mfma_f32_16x16x16_bf16 v[48:51], v[36:37], v[124:125], v[48:51]
v_mfma_f32_16x16x16_bf16 v[52:55], v[36:37], v[126:127], v[52:55]
v_cvt_pk_bf16_f32 v62, v24, v25
v_cvt_pk_bf16_f32 v63, v26, v27
v_cndmask_b32 v28, v28, v62, s[54:55]
v_cndmask_b32 v29, v29, v63, s[54:55]
v_lshlrev_b32 v38, 16, v28
v_and_b32 v39, 0xffff0000, v28
v_lshlrev_b32 v40, 16, v29
v_and_b32 v41, 0xffff0000, v29
v_mul_f32 v38, s56, v38
v_mul_f32 v39, s56, v39
v_mul_f32 v40, s56, v40
v_mul_f32 v41, s56, v41
v_cvt_pk_bf16_f32 v42, v38, v39
v_lshlrev_b32 v38, 16, v42
v_and_b32 v39, 0xffff0000, v42
v_cvt_pk_bf16_f32 v43, v40, v41
v_lshlrev_b32 v40, 16, v43
v_and_b32 v41, 0xffff0000, v43
v_max3_f32 v42, v38, v39, v40
v_max_f32 v42, v42, v41
v_cmp_gt_f32 vcc, v42, v46
s_cbranch_vccz L_grp_7
s_nop 1
v_max_f32_dpp v42, v42, v42 quad_perm:[1,0,3,2] row_mask:0xf bank_mask:0xf
s_nop 1
v_max_f32_dpp v42, v42, v42 quad_perm:[2,3,0,1] row_mask:0xf bank_mask:0xf
v_mov_b32 v43, v42
s_nop 1
v_permlane16_swap_b32 v42, v43
s_nop 1
v_max_f32 v42, v42, v43
v_mov_b32 v43, v42
s_nop 1
v_permlane32_swap_b32 v42, v43
s_nop 1
v_max_f32 v42, v42, v43
v_max_f32 v42, v42, v46
v_sub_f32 v43, v46, v42
v_mul_f32 v43, s57, v43
v_exp_f32 v43, v43
v_mov_b32 v46, v42
v_mul_f32 v3, s57, v42
v_sub_f32 v3, 0, v3
v_mul_f32 v47, v47, v43
v_mov_b32_dpp v44, v43 row_newbcast:0 row_mask:0x1 bank_mask:0xf
v_mov_b32_dpp v44, v43 row_newbcast:4 row_mask:0x2 bank_mask:0xf
v_mov_b32_dpp v44, v43 row_newbcast:8 row_mask:0x4 bank_mask:0xf
v_mov_b32_dpp v44, v43 row_newbcast:12 row_mask:0x8 bank_mask:0xf
v_mul_f32 v48, v48, v44
v_mul_f32 v49, v49, v44
v_mul_f32 v50, v50, v44
v_mul_f32 v51, v51, v44
v_mul_f32 v52, v52, v44
v_mul_f32 v53, v53, v44
v_mul_f32 v54, v54, v44
v_mul_f32 v55, v55, v44
L_grp_7:
v_fma_f32 v38, v38, s57, v3
v_fma_f32 v39, v39, s57, v3
v_fma_f32 v40, v40, s57, v3
v_fma_f32 v41, v41, s57, v3
v_exp_f32 v38, v38
v_exp_f32 v39, v39
v_exp_f32 v40, v40
v_exp_f32 v41, v41
s_nop 0
v_cvt_pk_bf16_f32 v56, v38, v38
v_cvt_pk_bf16_f32 v57, v39, v39
v_cvt_pk_bf16_f32 v58, v40, v40
v_cvt_pk_bf16_f32 v59, v41, v41
v_add_f32 v38, v38, v39
v_add_f32 v40, v40, v41
v_add_f32 v47, v47, v38
v_add_f32 v47, v47, v40
v_and_b32_dpp v30, v56, v60 quad_perm:[0,0,0,0] row_mask:0xf bank_mask:0xf
v_and_b32_dpp v31, v56, v61 quad_perm:[0,0,0,0] row_mask:0xf bank_mask:0xf
v_and_b32_dpp v32, v57, v60 quad_perm:[0,0,0,0] row_mask:0xf bank_mask:0xf
v_and_b32_dpp v33, v57, v61 quad_perm:[0,0,0,0] row_mask:0xf bank_mask:0xf
v_and_b32_dpp v34, v58, v60 quad_perm:[0,0,0,0] row_mask:0xf bank_mask:0xf
v_and_b32_dpp v35, v58, v61 quad_perm:[0,0,0,0] row_mask:0xf bank_mask:0xf
v_and_b32_dpp v36, v59, v60 quad_perm:[0,0,0,0] row_mask:0xf bank_mask:0xf
v_and_b32_dpp v37, v59, v61 quad_perm:[0,0,0,0] row_mask:0xf bank_mask:0xf
s_waitcnt vmcnt(12)
s_nop 0
v_mfma_f32_16x16x16_bf16 v[48:51], v[30:31], v[128:129], v[48:51]
v_mfma_f32_16x16x16_bf16 v[52:55], v[30:31], v[130:131], v[52:55]
v_mfma_f32_16x16x16_bf16 v[48:51], v[32:33], v[132:133], v[48:51]
v_mfma_f32_16x16x16_bf16 v[52:55], v[32:33], v[134:135], v[52:55]
v_mfma_f32_16x16x16_bf16 v[48:51], v[34:35], v[136:137], v[48:51]
v_mfma_f32_16x16x16_bf16 v[52:55], v[34:35], v[138:139], v[52:55]
v_mfma_f32_16x16x16_bf16 v[48:51], v[36:37], v[140:141], v[48:51]
v_mfma_f32_16x16x16_bf16 v[52:55], v[36:37], v[142:143], v[52:55]
v_and_b32_dpp v30, v56, v60 quad_perm:[1,1,1,1] row_mask:0xf bank_mask:0xf
v_and_b32_dpp v31, v56, v61 quad_perm:[1,1,1,1] row_mask:0xf bank_mask:0xf
v_and_b32_dpp v32, v57, v60 quad_perm:[1,1,1,1] row_mask:0xf bank_mask:0xf
v_and_b32_dpp v33, v57, v61 quad_perm:[1,1,1,1] row_mask:0xf bank_mask:0xf
v_and_b32_dpp v34, v58, v60 quad_perm:[1,1,1,1] row_mask:0xf bank_mask:0xf
v_and_b32_dpp v35, v58, v61 quad_perm:[1,1,1,1] row_mask:0xf bank_mask:0xf
v_and_b32_dpp v36, v59, v60 quad_perm:[1,1,1,1] row_mask:0xf bank_mask:0xf
v_and_b32_dpp v37, v59, v61 quad_perm:[1,1,1,1] row_mask:0xf bank_mask:0xf
s_waitcnt vmcnt(8)
s_nop 0
v_mfma_f32_16x16x16_bf16 v[48:51], v[30:31], v[144:145], v[48:51]
v_mfma_f32_16x16x16_bf16 v[52:55], v[30:31], v[146:147], v[52:55]
v_mfma_f32_16x16x16_bf16 v[48:51], v[32:33], v[148:149], v[48:51]
v_mfma_f32_16x16x16_bf16 v[52:55], v[32:33], v[150:151], v[52:55]
v_mfma_f32_16x16x16_bf16 v[48:51], v[34:35], v[152:153], v[48:51]
v_mfma_f32_16x16x16_bf16 v[52:55], v[34:35], v[154:155], v[52:55]
v_mfma_f32_16x16x16_bf16 v[48:51], v[36:37], v[156:157], v[48:51]
v_mfma_f32_16x16x16_bf16 v[52:55], v[36:37], v[158:159], v[52:55]
v_and_b32_dpp v30, v56, v60 quad_perm:[2,2,2,2] row_mask:0xf bank_mask:0xf
v_and_b32_dpp v31, v56, v61 quad_perm:[2,2,2,2] row_mask:0xf bank_mask:0xf
v_and_b32_dpp v32, v57, v60 quad_perm:[2,2,2,2] row_mask:0xf bank_mask:0xf
v_and_b32_dpp v33, v57, v61 quad_perm:[2,2,2,2] row_mask:0xf bank_mask:0xf
v_and_b32_dpp v34, v58, v60 quad_perm:[2,2,2,2] row_mask:0xf bank_mask:0xf
v_and_b32_dpp v35, v58, v61 quad_perm:[2,2,2,2] row_mask:0xf bank_mask:0xf
v_and_b32_dpp v36, v59, v60 quad_perm:[2,2,2,2] row_mask:0xf bank_mask:0xf
v_and_b32_dpp v37, v59, v61 quad_perm:[2,2,2,2] row_mask:0xf bank_mask:0xf
s_waitcnt vmcnt(4)
s_nop 0
v_mfma_f32_16x16x16_bf16 v[48:51], v[30:31], v[160:161], v[48:51]
v_mfma_f32_16x16x16_bf16 v[52:55], v[30:31], v[162:163], v[52:55]
v_mfma_f32_16x16x16_bf16 v[48:51], v[32:33], v[164:165], v[48:51]
v_mfma_f32_16x16x16_bf16 v[52:55], v[32:33], v[166:167], v[52:55]
v_mfma_f32_16x16x16_bf16 v[48:51], v[34:35], v[168:169], v[48:51]
v_mfma_f32_16x16x16_bf16 v[52:55], v[34:35], v[170:171], v[52:55]
v_mfma_f32_16x16x16_bf16 v[48:51], v[36:37], v[172:173], v[48:51]
v_mfma_f32_16x16x16_bf16 v[52:55], v[36:37], v[174:175], v[52:55]
s_nop 1
v_add_f32_dpp v47, v47, v47 quad_perm:[1,0,3,2] row_mask:0xf bank_mask:0xf
s_nop 1
v_add_f32_dpp v47, v47, v47 quad_perm:[2,3,0,1] row_mask:0xf bank_mask:0xf
v_mov_b32 v62, v47
s_nop 1
v_permlane16_swap_b32 v47, v62
s_nop 1
v_add_f32 v47, v47, v62
v_mov_b32 v62, v47
s_nop 1
v_permlane32_swap_b32 v47, v62
s_nop 1
v_add_f32 v47, v47, v62
s_lshl_b32 s45, s46, 11
s_add_u32 s45, s45, 1024
v_lshlrev_b32 v28, 5, v0
v_add_u32 v28, s45, v28
s_lshl_b32 s45, s46, 5
s_add_u32 s45, s45, 13312
v_bfe_u32 v29, v0, 2, 2
v_lshlrev_b32 v29, 3, v29
v_add_u32 v29, s45, v29
ds_write_b64 v29, v[46:47]
v_and_b32_dpp v30, v56, v60 quad_perm:[3,3,3,3] row_mask:0xf bank_mask:0xf
v_and_b32_dpp v31, v56, v61 quad_perm:[3,3,3,3] row_mask:0xf bank_mask:0xf
v_and_b32_dpp v32, v57, v60 quad_perm:[3,3,3,3] row_mask:0xf bank_mask:0xf
v_and_b32_dpp v33, v57, v61 quad_perm:[3,3,3,3] row_mask:0xf bank_mask:0xf
v_and_b32_dpp v34, v58, v60 quad_perm:[3,3,3,3] row_mask:0xf bank_mask:0xf
v_and_b32_dpp v35, v58, v61 quad_perm:[3,3,3,3] row_mask:0xf bank_mask:0xf
v_and_b32_dpp v36, v59, v60 quad_perm:[3,3,3,3] row_mask:0xf bank_mask:0xf
v_and_b32_dpp v37, v59, v61 quad_perm:[3,3,3,3] row_mask:0xf bank_mask:0xf
s_waitcnt vmcnt(0)
s_nop 0
v_mfma_f32_16x16x16_bf16 v[48:51], v[30:31], v[176:177], v[48:51]
v_mfma_f32_16x16x16_bf16 v[52:55], v[30:31], v[178:179], v[52:55]
v_mfma_f32_16x16x16_bf16 v[48:51], v[32:33], v[180:181], v[48:51]
v_mfma_f32_16x16x16_bf16 v[52:55], v[32:33], v[182:183], v[52:55]
v_mfma_f32_16x16x16_bf16 v[48:51], v[34:35], v[184:185], v[48:51]
v_mfma_f32_16x16x16_bf16 v[52:55], v[34:35], v[186:187], v[52:55]
v_mfma_f32_16x16x16_bf16 v[48:51], v[36:37], v[188:189], v[48:51]
v_mfma_f32_16x16x16_bf16 v[52:55], v[36:37], v[190:191], v[52:55]
L_seg_h:
s_nop 6
ds_write_b128 v28, v[48:51]
ds_write_b128 v28, v[52:55] offset:16
s_waitcnt lgkmcnt(0)
s_barrier
s_mov_b32 s52, s16
s_and_b32 s53, s17, 0xffff
s_mov_b32 s54, 0xe00
s_mov_b32 s55, 0x20000
s_mov_b32 s56, s18
s_and_b32 s57, s19, 0xffff
s_mov_b32 s58, 0xe00
s_mov_b32 s59, 0x20000
s_mov_b32 s60, s20
s_and_b32 s61, s21, 0xffff
s_mov_b32 s62, 0xe00
s_mov_b32 s63, 0x20000
v_lshlrev_b32 v4, 3, v0
s_lshl_b32 s14, s30, 9
buffer_load_dwordx2 v[234:235], v4, s[52:55], s14 offen
buffer_load_dwordx2 v[236:237], v4, s[56:59], s14 offen
buffer_load_dwordx2 v[232:233], v4, s[60:63], s14 offen
s_mov_b32 s44, s28
s_and_b32 s45, s29, 0xffff
s_mov_b32 s46, 0x20000000
s_mov_b32 s47, 0x20000
s_mov_b32 s68, s24
s_and_b32 s69, s25, 0xffff
s_mov_b32 s70, 0x400
s_mov_b32 s71, 0x20000
s_barrier
s_waitcnt vmcnt(0)
v_mov_b32 v149, 14592
v_lshlrev_b32 v224, 16, v234
v_and_b32 v225, 0xffff0000, v234
v_lshlrev_b32 v228, 16, v236
v_and_b32 v229, 0xffff0000, v236
v_mov_b32 v238, 0xc0135761
v_mov_b32 v240, 0xbdd2d3e8
v_mov_b32 v242, 1.0
v_lshlrev_b32 v226, 16, v235
v_and_b32 v227, 0xffff0000, v235
v_lshlrev_b32 v230, 16, v237
v_and_b32 v231, 0xffff0000, v237
v_mov_b32 v239, 0xc0135761
v_mov_b32 v241, 0xbdd2d3e8
v_mov_b32 v243, 1.0
s_branch L_b4
L_cover:
v_and_b32 v4, 3, v0
v_lshlrev_b32 v4, 10, v4
v_bfe_u32 v5, v0, 2, 2
v_lshlrev_b32 v5, 8, v5
v_lshrrev_b32 v6, 4, v0
v_lshlrev_b32 v6, 4, v6
v_add3_u32 v1, v4, v5, v6
v_lshlrev_b32 v2, 4, v0
s_lshl_b32 s44, s31, 24
s_lshl_b32 s45, s32, 19
s_add_u32 s44, s44, s45
s_setprio 2
s_sub_u32 s46, s30, 2
s_lshl_b32 s45, s46, 12
s_add_u32 s44, s44, s45
s_waitcnt lgkmcnt(0)
s_mov_b32 s36, s6
s_and_b32 s37, s7, 0xffff
s_mov_b32 s38, 0x8000000
s_mov_b32 s39, 0x20000
s_mov_b32 s40, s8
s_and_b32 s41, s9, 0xffff
s_mov_b32 s42, 0x8000000
s_mov_b32 s43, 0x20000
s_add_u32 s45, s44, 0x0
buffer_load_dwordx4 v[64:67], v1, s[36:39], s45 offen offset:0 nt
buffer_load_dwordx4 v[68:71], v1, s[36:39], s45 offen offset:64 nt
buffer_load_dwordx4 v[72:75], v1, s[36:39], s45 offen offset:128 nt
buffer_load_dwordx4 v[76:79], v1, s[36:39], s45 offen offset:192 nt
s_add_u32 s45, s44, 0x6000
buffer_load_dwordx4 v[80:83], v1, s[36:39], s45 offen offset:0 nt
buffer_load_dwordx4 v[84:87], v1, s[36:39], s45 offen offset:64 nt
buffer_load_dwordx4 v[88:91], v1, s[36:39], s45 offen offset:128 nt
buffer_load_dwordx4 v[92:95], v1, s[36:39], s45 offen offset:192 nt
s_barrier
s_mov_b32 s48, 0x11111111
s_mov_b32 s49, 0x11111111
s_mov_b32 s50, 0x22222222
s_mov_b32 s51, 0x22222222
s_mov_b32 s52, 0x44444444
s_mov_b32 s53, 0x44444444
s_mov_b32 s54, 0x88888888
s_mov_b32 s55, 0x88888888
s_mov_b32 s56, 0x3db504f3
s_mov_b32 s57, 0x3fb8aa3b
v_and_b32 v4, 1, v0
v_lshlrev_b32 v4, 4, v4
v_mov_b32 v5, 0xffff
v_lshlrev_b32 v5, v4, v5
v_and_b32 v4, 2, v0
v_cmp_eq_u32 vcc, 0, v4
v_mov_b32 v6, 0
s_nop 0
v_cndmask_b32 v60, v6, v5, vcc
v_cndmask_b32 v61, v5, v6, vcc
v_mov_b32 v46, 0xff800000
v_mov_b32 v47, 0
v_mov_b32 v48, 0
v_mov_b32 v49, 0
v_mov_b32 v50, 0
v_mov_b32 v51, 0
v_mov_b32 v52, 0
v_mov_b32 v53, 0
v_mov_b32 v54, 0
v_mov_b32 v55, 0
v_bfe_u32 v62, v0, 2, 2
v_lshlrev_b32 v62, 8, v62
v_lshrrev_b32 v63, 4, v0
v_lshl_add_u32 v62, v63, 4, v62
s_waitcnt vmcnt(4)
s_add_u32 s45, s44, 0xc000
buffer_load_dwordx4 v[96:99], v1, s[36:39], s45 offen offset:0 nt
buffer_load_dwordx4 v[100:103], v1, s[36:39], s45 offen offset:64 nt
buffer_load_dwordx4 v[104:107], v1, s[36:39], s45 offen offset:128 nt
buffer_load_dwordx4 v[108:111], v1, s[36:39], s45 offen offset:192 nt
s_waitcnt vmcnt(4)
s_add_u32 s45, s44, 0x12000
buffer_load_dwordx4 v[112:115], v1, s[36:39], s45 offen offset:0 nt
buffer_load_dwordx4 v[116:119], v1, s[36:39], s45 offen offset:64 nt
buffer_load_dwordx4 v[120:123], v1, s[36:39], s45 offen offset:128 nt
buffer_load_dwordx4 v[124:127], v1, s[36:39], s45 offen offset:192 nt
s_waitcnt vmcnt(4)
s_add_u32 s45, s44, 0x18000
buffer_load_dwordx4 v[128:131], v1, s[36:39], s45 offen offset:0 nt
buffer_load_dwordx4 v[132:135], v1, s[36:39], s45 offen offset:64 nt
buffer_load_dwordx4 v[136:139], v1, s[36:39], s45 offen offset:128 nt
buffer_load_dwordx4 v[140:143], v1, s[36:39], s45 offen offset:192 nt
s_waitcnt vmcnt(4)
s_add_u32 s45, s44, 0x0
buffer_load_dwordx4 v[144:147], v2, s[40:43], s45 offen offset:0 nt
buffer_load_dwordx4 v[148:151], v2, s[40:43], s45 offen offset:1024 nt
buffer_load_dwordx4 v[152:155], v2, s[40:43], s45 offen offset:2048 nt
buffer_load_dwordx4 v[156:159], v2, s[40:43], s45 offen offset:3072 nt
s_waitcnt vmcnt(4)
s_add_u32 s45, s44, 0x1e000
buffer_load_dwordx4 v[160:163], v1, s[36:39], s45 offen offset:0 nt
buffer_load_dwordx4 v[164:167], v1, s[36:39], s45 offen offset:64 nt
buffer_load_dwordx4 v[168:171], v1, s[36:39], s45 offen offset:128 nt
buffer_load_dwordx4 v[172:175], v1, s[36:39], s45 offen offset:192 nt
s_waitcnt vmcnt(4)
s_add_u32 s45, s44, 0x6000
buffer_load_dwordx4 v[176:179], v2, s[40:43], s45 offen offset:0 nt
buffer_load_dwordx4 v[180:183], v2, s[40:43], s45 offen offset:1024 nt
buffer_load_dwordx4 v[184:187], v2, s[40:43], s45 offen offset:2048 nt
buffer_load_dwordx4 v[188:191], v2, s[40:43], s45 offen offset:3072 nt
s_waitcnt vmcnt(4)
s_add_u32 s45, s44, 0x24000
buffer_load_dwordx4 v[192:195], v1, s[36:39], s45 offen offset:0 nt
buffer_load_dwordx4 v[196:199], v1, s[36:39], s45 offen offset:64 nt
buffer_load_dwordx4 v[200:203], v1, s[36:39], s45 offen offset:128 nt
buffer_load_dwordx4 v[204:207], v1, s[36:39], s45 offen offset:192 nt
s_waitcnt vmcnt(4)
s_add_u32 s45, s44, 0xc000
buffer_load_dwordx4 v[208:211], v2, s[40:43], s45 offen offset:0 nt
buffer_load_dwordx4 v[212:215], v2, s[40:43], s45 offen offset:1024 nt
buffer_load_dwordx4 v[216:219], v2, s[40:43], s45 offen offset:2048 nt
buffer_load_dwordx4 v[220:223], v2, s[40:43], s45 offen offset:3072 nt
s_waitcnt vmcnt(4)
s_add_u32 s45, s44, 0x2a000
buffer_load_dwordx4 v[224:227], v1, s[36:39], s45 offen offset:0 nt
buffer_load_dwordx4 v[228:231], v1, s[36:39], s45 offen offset:64 nt
buffer_load_dwordx4 v[232:235], v1, s[36:39], s45 offen offset:128 nt
buffer_load_dwordx4 v[236:239], v1, s[36:39], s45 offen offset:192 nt
s_waitcnt vmcnt(4)
s_add_u32 s45, s44, 0x12000
buffer_load_dwordx4 v[240:243], v2, s[40:43], s45 offen offset:0 nt
buffer_load_dwordx4 v[244:247], v2, s[40:43], s45 offen offset:1024 nt
buffer_load_dwordx4 v[248:251], v2, s[40:43], s45 offen offset:2048 nt
buffer_load_dwordx4 v[252:255], v2, s[40:43], s45 offen offset:3072 nt
s_barrier
ds_read_b128 v[4:7], v62 offset:0
ds_read_b128 v[8:11], v62 offset:64
ds_read_b128 v[12:15], v62 offset:128
ds_read_b128 v[16:19], v62 offset:192
s_waitcnt lgkmcnt(0)
s_waitcnt vmcnt(44)
v_mfma_f32_16x16x32_bf16 v[20:23], v[64:67], v[4:7], 0
v_mfma_f32_16x16x32_bf16 v[20:23], v[68:71], v[8:11], v[20:23]
v_mfma_f32_16x16x32_bf16 v[20:23], v[72:75], v[12:15], v[20:23]
v_mfma_f32_16x16x32_bf16 v[20:23], v[76:79], v[16:19], v[20:23]
s_add_u32 s45, s44, 0x18000
buffer_load_dwordx4 v[64:67], v2, s[40:43], s45 offen offset:0 nt
buffer_load_dwordx4 v[68:71], v2, s[40:43], s45 offen offset:1024 nt
buffer_load_dwordx4 v[72:75], v2, s[40:43], s45 offen offset:2048 nt
buffer_load_dwordx4 v[76:79], v2, s[40:43], s45 offen offset:3072 nt
s_waitcnt vmcnt(44)
v_mfma_f32_16x16x32_bf16 v[24:27], v[80:83], v[4:7], 0
v_mfma_f32_16x16x32_bf16 v[24:27], v[84:87], v[8:11], v[24:27]
v_mfma_f32_16x16x32_bf16 v[24:27], v[88:91], v[12:15], v[24:27]
v_mfma_f32_16x16x32_bf16 v[24:27], v[92:95], v[16:19], v[24:27]
s_nop 4
v_cvt_pk_bf16_f32 v28, v20, v21
v_cvt_pk_bf16_f32 v29, v22, v23
s_waitcnt vmcnt(40)
v_mfma_f32_16x16x32_bf16 v[20:23], v[96:99], v[4:7], 0
v_mfma_f32_16x16x32_bf16 v[20:23], v[100:103], v[8:11], v[20:23]
v_mfma_f32_16x16x32_bf16 v[20:23], v[104:107], v[12:15], v[20:23]
v_mfma_f32_16x16x32_bf16 v[20:23], v[108:111], v[16:19], v[20:23]
s_add_u32 s45, s44, 0x1e000
buffer_load_dwordx4 v[80:83], v2, s[40:43], s45 offen offset:0 nt
buffer_load_dwordx4 v[84:87], v2, s[40:43], s45 offen offset:1024 nt
buffer_load_dwordx4 v[88:91], v2, s[40:43], s45 offen offset:2048 nt
buffer_load_dwordx4 v[92:95], v2, s[40:43], s45 offen offset:3072 nt
v_cvt_pk_bf16_f32 v62, v24, v25
v_cvt_pk_bf16_f32 v63, v26, v27
v_cndmask_b32 v28, v28, v62, s[50:51]
v_cndmask_b32 v29, v29, v63, s[50:51]
s_waitcnt vmcnt(40)
v_mfma_f32_16x16x32_bf16 v[24:27], v[112:115], v[4:7], 0
v_mfma_f32_16x16x32_bf16 v[24:27], v[116:119], v[8:11], v[24:27]
v_mfma_f32_16x16x32_bf16 v[24:27], v[120:123], v[12:15], v[24:27]
v_mfma_f32_16x16x32_bf16 v[24:27], v[124:127], v[16:19], v[24:27]
s_nop 4
v_cvt_pk_bf16_f32 v62, v20, v21
v_cvt_pk_bf16_f32 v63, v22, v23
v_cndmask_b32 v28, v28, v62, s[52:53]
v_cndmask_b32 v29, v29, v63, s[52:53]
s_nop 3
v_cvt_pk_bf16_f32 v62, v24, v25
v_cvt_pk_bf16_f32 v63, v26, v27
v_cndmask_b32 v28, v28, v62, s[54:55]
v_cndmask_b32 v29, v29, v63, s[54:55]
v_lshlrev_b32 v38, 16, v28
v_and_b32 v39, 0xffff0000, v28
v_lshlrev_b32 v40, 16, v29
v_and_b32 v41, 0xffff0000, v29
v_mul_f32 v38, s56, v38
v_mul_f32 v39, s56, v39
v_mul_f32 v40, s56, v40
v_mul_f32 v41, s56, v41
v_cvt_pk_bf16_f32 v42, v38, v39
v_lshlrev_b32 v38, 16, v42
v_and_b32 v39, 0xffff0000, v42
v_cvt_pk_bf16_f32 v43, v40, v41
v_lshlrev_b32 v40, 16, v43
v_and_b32 v41, 0xffff0000, v43
v_max3_f32 v42, v38, v39, v40
v_max_f32 v42, v42, v41
v_cmp_gt_f32 vcc, v42, v46
s_cbranch_vccz L_grp_8
s_nop 1
v_max_f32_dpp v42, v42, v42 quad_perm:[1,0,3,2] row_mask:0xf bank_mask:0xf
s_nop 1
v_max_f32_dpp v42, v42, v42 quad_perm:[2,3,0,1] row_mask:0xf bank_mask:0xf
v_mov_b32 v43, v42
s_nop 1
v_permlane16_swap_b32 v42, v43
s_nop 1
v_max_f32 v42, v42, v43
v_mov_b32 v43, v42
s_nop 1
v_permlane32_swap_b32 v42, v43
s_nop 1
v_max_f32 v42, v42, v43
v_max_f32 v42, v42, v46
v_sub_f32 v43, v46, v42
v_mul_f32 v43, s57, v43
v_exp_f32 v43, v43
v_mov_b32 v46, v42
v_mul_f32 v3, s57, v42
v_sub_f32 v3, 0, v3
v_mul_f32 v47, v47, v43
v_mov_b32_dpp v44, v43 row_newbcast:0 row_mask:0x1 bank_mask:0xf
v_mov_b32_dpp v44, v43 row_newbcast:4 row_mask:0x2 bank_mask:0xf
v_mov_b32_dpp v44, v43 row_newbcast:8 row_mask:0x4 bank_mask:0xf
v_mov_b32_dpp v44, v43 row_newbcast:12 row_mask:0x8 bank_mask:0xf
v_mul_f32 v48, v48, v44
v_mul_f32 v49, v49, v44
v_mul_f32 v50, v50, v44
v_mul_f32 v51, v51, v44
v_mul_f32 v52, v52, v44
v_mul_f32 v53, v53, v44
v_mul_f32 v54, v54, v44
v_mul_f32 v55, v55, v44
L_grp_8:
v_fma_f32 v38, v38, s57, v3
v_fma_f32 v39, v39, s57, v3
v_fma_f32 v40, v40, s57, v3
v_fma_f32 v41, v41, s57, v3
v_exp_f32 v38, v38
v_exp_f32 v39, v39
v_exp_f32 v40, v40
v_exp_f32 v41, v41
s_nop 0
v_cvt_pk_bf16_f32 v56, v38, v38
v_cvt_pk_bf16_f32 v57, v39, v39
v_cvt_pk_bf16_f32 v58, v40, v40
v_cvt_pk_bf16_f32 v59, v41, v41
v_add_f32 v38, v38, v39
v_add_f32 v40, v40, v41
v_add_f32 v47, v47, v38
v_add_f32 v47, v47, v40
s_waitcnt vmcnt(36)
v_mfma_f32_16x16x32_bf16 v[20:23], v[128:131], v[4:7], 0
v_mfma_f32_16x16x32_bf16 v[20:23], v[132:135], v[8:11], v[20:23]
v_mfma_f32_16x16x32_bf16 v[20:23], v[136:139], v[12:15], v[20:23]
v_mfma_f32_16x16x32_bf16 v[20:23], v[140:143], v[16:19], v[20:23]
s_add_u32 s45, s44, 0x24000
buffer_load_dwordx4 v[96:99], v2, s[40:43], s45 offen offset:0 nt
buffer_load_dwordx4 v[100:103], v2, s[40:43], s45 offen offset:1024 nt
buffer_load_dwordx4 v[104:107], v2, s[40:43], s45 offen offset:2048 nt
buffer_load_dwordx4 v[108:111], v2, s[40:43], s45 offen offset:3072 nt
v_and_b32_dpp v30, v56, v60 quad_perm:[0,0,0,0] row_mask:0xf bank_mask:0xf
v_and_b32_dpp v31, v56, v61 quad_perm:[0,0,0,0] row_mask:0xf bank_mask:0xf
v_and_b32_dpp v32, v57, v60 quad_perm:[0,0,0,0] row_mask:0xf bank_mask:0xf
v_and_b32_dpp v33, v57, v61 quad_perm:[0,0,0,0] row_mask:0xf bank_mask:0xf
v_and_b32_dpp v34, v58, v60 quad_perm:[0,0,0,0] row_mask:0xf bank_mask:0xf
v_and_b32_dpp v35, v58, v61 quad_perm:[0,0,0,0] row_mask:0xf bank_mask:0xf
v_and_b32_dpp v36, v59, v60 quad_perm:[0,0,0,0] row_mask:0xf bank_mask:0xf
v_and_b32_dpp v37, v59, v61 quad_perm:[0,0,0,0] row_mask:0xf bank_mask:0xf
s_waitcnt vmcnt(36)
s_nop 0
v_mfma_f32_16x16x16_bf16 v[48:51], v[30:31], v[144:145], v[48:51]
v_mfma_f32_16x16x16_bf16 v[52:55], v[30:31], v[146:147], v[52:55]
v_mfma_f32_16x16x16_bf16 v[48:51], v[32:33], v[148:149], v[48:51]
v_mfma_f32_16x16x16_bf16 v[52:55], v[32:33], v[150:151], v[52:55]
v_mfma_f32_16x16x16_bf16 v[48:51], v[34:35], v[152:153], v[48:51]
v_mfma_f32_16x16x16_bf16 v[52:55], v[34:35], v[154:155], v[52:55]
v_mfma_f32_16x16x16_bf16 v[48:51], v[36:37], v[156:157], v[48:51]
v_mfma_f32_16x16x16_bf16 v[52:55], v[36:37], v[158:159], v[52:55]
v_cvt_pk_bf16_f32 v28, v20, v21
v_cvt_pk_bf16_f32 v29, v22, v23
s_waitcnt vmcnt(32)
v_mfma_f32_16x16x32_bf16 v[24:27], v[160:163], v[4:7], 0
v_mfma_f32_16x16x32_bf16 v[24:27], v[164:167], v[8:11], v[24:27]
v_mfma_f32_16x16x32_bf16 v[24:27], v[168:171], v[12:15], v[24:27]
v_mfma_f32_16x16x32_bf16 v[24:27], v[172:175], v[16:19], v[24:27]
s_add_u32 s45, s44, 0x2a000
buffer_load_dwordx4 v[112:115], v2, s[40:43], s45 offen offset:0 nt
buffer_load_dwordx4 v[116:119], v2, s[40:43], s45 offen offset:1024 nt
buffer_load_dwordx4 v[120:123], v2, s[40:43], s45 offen offset:2048 nt
buffer_load_dwordx4 v[124:127], v2, s[40:43], s45 offen offset:3072 nt
v_and_b32_dpp v30, v56, v60 quad_perm:[1,1,1,1] row_mask:0xf bank_mask:0xf
v_and_b32_dpp v31, v56, v61 quad_perm:[1,1,1,1] row_mask:0xf bank_mask:0xf
v_and_b32_dpp v32, v57, v60 quad_perm:[1,1,1,1] row_mask:0xf bank_mask:0xf
v_and_b32_dpp v33, v57, v61 quad_perm:[1,1,1,1] row_mask:0xf bank_mask:0xf
v_and_b32_dpp v34, v58, v60 quad_perm:[1,1,1,1] row_mask:0xf bank_mask:0xf
v_and_b32_dpp v35, v58, v61 quad_perm:[1,1,1,1] row_mask:0xf bank_mask:0xf
v_and_b32_dpp v36, v59, v60 quad_perm:[1,1,1,1] row_mask:0xf bank_mask:0xf
v_and_b32_dpp v37, v59, v61 quad_perm:[1,1,1,1] row_mask:0xf bank_mask:0xf
s_waitcnt vmcnt(32)
s_nop 0
v_mfma_f32_16x16x16_bf16 v[48:51], v[30:31], v[176:177], v[48:51]
v_mfma_f32_16x16x16_bf16 v[52:55], v[30:31], v[178:179], v[52:55]
v_mfma_f32_16x16x16_bf16 v[48:51], v[32:33], v[180:181], v[48:51]
v_mfma_f32_16x16x16_bf16 v[52:55], v[32:33], v[182:183], v[52:55]
v_mfma_f32_16x16x16_bf16 v[48:51], v[34:35], v[184:185], v[48:51]
v_mfma_f32_16x16x16_bf16 v[52:55], v[34:35], v[186:187], v[52:55]
v_mfma_f32_16x16x16_bf16 v[48:51], v[36:37], v[188:189], v[48:51]
v_mfma_f32_16x16x16_bf16 v[52:55], v[36:37], v[190:191], v[52:55]
v_cvt_pk_bf16_f32 v62, v24, v25
v_cvt_pk_bf16_f32 v63, v26, v27
v_cndmask_b32 v28, v28, v62, s[50:51]
v_cndmask_b32 v29, v29, v63, s[50:51]
s_waitcnt vmcnt(28)
v_mfma_f32_16x16x32_bf16 v[20:23], v[192:195], v[4:7], 0
v_mfma_f32_16x16x32_bf16 v[20:23], v[196:199], v[8:11], v[20:23]
v_mfma_f32_16x16x32_bf16 v[20:23], v[200:203], v[12:15], v[20:23]
v_mfma_f32_16x16x32_bf16 v[20:23], v[204:207], v[16:19], v[20:23]
s_nop 4
v_and_b32_dpp v30, v56, v60 quad_perm:[2,2,2,2] row_mask:0xf bank_mask:0xf
v_and_b32_dpp v31, v56, v61 quad_perm:[2,2,2,2] row_mask:0xf bank_mask:0xf
v_and_b32_dpp v32, v57, v60 quad_perm:[2,2,2,2] row_mask:0xf bank_mask:0xf
v_and_b32_dpp v33, v57, v61 quad_perm:[2,2,2,2] row_mask:0xf bank_mask:0xf
v_and_b32_dpp v34, v58, v60 quad_perm:[2,2,2,2] row_mask:0xf bank_mask:0xf
v_and_b32_dpp v35, v58, v61 quad_perm:[2,2,2,2] row_mask:0xf bank_mask:0xf
v_and_b32_dpp v36, v59, v60 quad_perm:[2,2,2,2] row_mask:0xf bank_mask:0xf
v_and_b32_dpp v37, v59, v61 quad_perm:[2,2,2,2] row_mask:0xf bank_mask:0xf
s_waitcnt vmcnt(24)
s_nop 0
v_mfma_f32_16x16x16_bf16 v[48:51], v[30:31], v[208:209], v[48:51]
v_mfma_f32_16x16x16_bf16 v[52:55], v[30:31], v[210:211], v[52:55]
v_mfma_f32_16x16x16_bf16 v[48:51], v[32:33], v[212:213], v[48:51]
v_mfma_f32_16x16x16_bf16 v[52:55], v[32:33], v[214:215], v[52:55]
v_mfma_f32_16x16x16_bf16 v[48:51], v[34:35], v[216:217], v[48:51]
v_mfma_f32_16x16x16_bf16 v[52:55], v[34:35], v[218:219], v[52:55]
v_mfma_f32_16x16x16_bf16 v[48:51], v[36:37], v[220:221], v[48:51]
v_mfma_f32_16x16x16_bf16 v[52:55], v[36:37], v[222:223], v[52:55]
v_cvt_pk_bf16_f32 v62, v20, v21
v_cvt_pk_bf16_f32 v63, v22, v23
v_cndmask_b32 v28, v28, v62, s[52:53]
v_cndmask_b32 v29, v29, v63, s[52:53]
s_waitcnt vmcnt(20)
v_mfma_f32_16x16x32_bf16 v[24:27], v[224:227], v[4:7], 0
v_mfma_f32_16x16x32_bf16 v[24:27], v[228:231], v[8:11], v[24:27]
v_mfma_f32_16x16x32_bf16 v[24:27], v[232:235], v[12:15], v[24:27]
v_mfma_f32_16x16x32_bf16 v[24:27], v[236:239], v[16:19], v[24:27]
s_nop 4
v_and_b32_dpp v30, v56, v60 quad_perm:[3,3,3,3] row_mask:0xf bank_mask:0xf
v_and_b32_dpp v31, v56, v61 quad_perm:[3,3,3,3] row_mask:0xf bank_mask:0xf
v_and_b32_dpp v32, v57, v60 quad_perm:[3,3,3,3] row_mask:0xf bank_mask:0xf
v_and_b32_dpp v33, v57, v61 quad_perm:[3,3,3,3] row_mask:0xf bank_mask:0xf
v_and_b32_dpp v34, v58, v60 quad_perm:[3,3,3,3] row_mask:0xf bank_mask:0xf
v_and_b32_dpp v35, v58, v61 quad_perm:[3,3,3,3] row_mask:0xf bank_mask:0xf
v_and_b32_dpp v36, v59, v60 quad_perm:[3,3,3,3] row_mask:0xf bank_mask:0xf
v_and_b32_dpp v37, v59, v61 quad_perm:[3,3,3,3] row_mask:0xf bank_mask:0xf
s_waitcnt vmcnt(16)
s_nop 0
v_mfma_f32_16x16x16_bf16 v[48:51], v[30:31], v[240:241], v[48:51]
v_mfma_f32_16x16x16_bf16 v[52:55], v[30:31], v[242:243], v[52:55]
v_mfma_f32_16x16x16_bf16 v[48:51], v[32:33], v[244:245], v[48:51]
v_mfma_f32_16x16x16_bf16 v[52:55], v[32:33], v[246:247], v[52:55]
v_mfma_f32_16x16x16_bf16 v[48:51], v[34:35], v[248:249], v[48:51]
v_mfma_f32_16x16x16_bf16 v[52:55], v[34:35], v[250:251], v[52:55]
v_mfma_f32_16x16x16_bf16 v[48:51], v[36:37], v[252:253], v[48:51]
v_mfma_f32_16x16x16_bf16 v[52:55], v[36:37], v[254:255], v[52:55]
v_cvt_pk_bf16_f32 v62, v24, v25
v_cvt_pk_bf16_f32 v63, v26, v27
v_cndmask_b32 v28, v28, v62, s[54:55]
v_cndmask_b32 v29, v29, v63, s[54:55]
v_lshlrev_b32 v38, 16, v28
v_and_b32 v39, 0xffff0000, v28
v_lshlrev_b32 v40, 16, v29
v_and_b32 v41, 0xffff0000, v29
v_mul_f32 v38, s56, v38
v_mul_f32 v39, s56, v39
v_mul_f32 v40, s56, v40
v_mul_f32 v41, s56, v41
v_cvt_pk_bf16_f32 v42, v38, v39
v_lshlrev_b32 v38, 16, v42
v_and_b32 v39, 0xffff0000, v42
v_cvt_pk_bf16_f32 v43, v40, v41
v_lshlrev_b32 v40, 16, v43
v_and_b32 v41, 0xffff0000, v43
v_max3_f32 v42, v38, v39, v40
v_max_f32 v42, v42, v41
v_cmp_gt_f32 vcc, v42, v46
s_cbranch_vccz L_grp_9
s_nop 1
v_max_f32_dpp v42, v42, v42 quad_perm:[1,0,3,2] row_mask:0xf bank_mask:0xf
s_nop 1
v_max_f32_dpp v42, v42, v42 quad_perm:[2,3,0,1] row_mask:0xf bank_mask:0xf
v_mov_b32 v43, v42
s_nop 1
v_permlane16_swap_b32 v42, v43
s_nop 1
v_max_f32 v42, v42, v43
v_mov_b32 v43, v42
s_nop 1
v_permlane32_swap_b32 v42, v43
s_nop 1
v_max_f32 v42, v42, v43
v_max_f32 v42, v42, v46
v_sub_f32 v43, v46, v42
v_mul_f32 v43, s57, v43
v_exp_f32 v43, v43
v_mov_b32 v46, v42
v_mul_f32 v3, s57, v42
v_sub_f32 v3, 0, v3
v_mul_f32 v47, v47, v43
v_mov_b32_dpp v44, v43 row_newbcast:0 row_mask:0x1 bank_mask:0xf
v_mov_b32_dpp v44, v43 row_newbcast:4 row_mask:0x2 bank_mask:0xf
v_mov_b32_dpp v44, v43 row_newbcast:8 row_mask:0x4 bank_mask:0xf
v_mov_b32_dpp v44, v43 row_newbcast:12 row_mask:0x8 bank_mask:0xf
v_mul_f32 v48, v48, v44
v_mul_f32 v49, v49, v44
v_mul_f32 v50, v50, v44
v_mul_f32 v51, v51, v44
v_mul_f32 v52, v52, v44
v_mul_f32 v53, v53, v44
v_mul_f32 v54, v54, v44
v_mul_f32 v55, v55, v44
L_grp_9:
v_fma_f32 v38, v38, s57, v3
v_fma_f32 v39, v39, s57, v3
v_fma_f32 v40, v40, s57, v3
v_fma_f32 v41, v41, s57, v3
v_exp_f32 v38, v38
v_exp_f32 v39, v39
v_exp_f32 v40, v40
v_exp_f32 v41, v41
s_nop 0
v_cvt_pk_bf16_f32 v56, v38, v38
v_cvt_pk_bf16_f32 v57, v39, v39
v_cvt_pk_bf16_f32 v58, v40, v40
v_cvt_pk_bf16_f32 v59, v41, v41
v_add_f32 v38, v38, v39
v_add_f32 v40, v40, v41
v_add_f32 v47, v47, v38
v_add_f32 v47, v47, v40
v_and_b32_dpp v30, v56, v60 quad_perm:[0,0,0,0] row_mask:0xf bank_mask:0xf
v_and_b32_dpp v31, v56, v61 quad_perm:[0,0,0,0] row_mask:0xf bank_mask:0xf
v_and_b32_dpp v32, v57, v60 quad_perm:[0,0,0,0] row_mask:0xf bank_mask:0xf
v_and_b32_dpp v33, v57, v61 quad_perm:[0,0,0,0] row_mask:0xf bank_mask:0xf
v_and_b32_dpp v34, v58, v60 quad_perm:[0,0,0,0] row_mask:0xf bank_mask:0xf
v_and_b32_dpp v35, v58, v61 quad_perm:[0,0,0,0] row_mask:0xf bank_mask:0xf
v_and_b32_dpp v36, v59, v60 quad_perm:[0,0,0,0] row_mask:0xf bank_mask:0xf
v_and_b32_dpp v37, v59, v61 quad_perm:[0,0,0,0] row_mask:0xf bank_mask:0xf
s_waitcnt vmcnt(12)
s_nop 0
v_mfma_f32_16x16x16_bf16 v[48:51], v[30:31], v[64:65], v[48:51]
v_mfma_f32_16x16x16_bf16 v[52:55], v[30:31], v[66:67], v[52:55]
v_mfma_f32_16x16x16_bf16 v[48:51], v[32:33], v[68:69], v[48:51]
v_mfma_f32_16x16x16_bf16 v[52:55], v[32:33], v[70:71], v[52:55]
v_mfma_f32_16x16x16_bf16 v[48:51], v[34:35], v[72:73], v[48:51]
v_mfma_f32_16x16x16_bf16 v[52:55], v[34:35], v[74:75], v[52:55]
v_mfma_f32_16x16x16_bf16 v[48:51], v[36:37], v[76:77], v[48:51]
v_mfma_f32_16x16x16_bf16 v[52:55], v[36:37], v[78:79], v[52:55]
v_and_b32_dpp v30, v56, v60 quad_perm:[1,1,1,1] row_mask:0xf bank_mask:0xf
v_and_b32_dpp v31, v56, v61 quad_perm:[1,1,1,1] row_mask:0xf bank_mask:0xf
v_and_b32_dpp v32, v57, v60 quad_perm:[1,1,1,1] row_mask:0xf bank_mask:0xf
v_and_b32_dpp v33, v57, v61 quad_perm:[1,1,1,1] row_mask:0xf bank_mask:0xf
v_and_b32_dpp v34, v58, v60 quad_perm:[1,1,1,1] row_mask:0xf bank_mask:0xf
v_and_b32_dpp v35, v58, v61 quad_perm:[1,1,1,1] row_mask:0xf bank_mask:0xf
v_and_b32_dpp v36, v59, v60 quad_perm:[1,1,1,1] row_mask:0xf bank_mask:0xf
v_and_b32_dpp v37, v59, v61 quad_perm:[1,1,1,1] row_mask:0xf bank_mask:0xf
s_waitcnt vmcnt(8)
s_nop 0
v_mfma_f32_16x16x16_bf16 v[48:51], v[30:31], v[80:81], v[48:51]
v_mfma_f32_16x16x16_bf16 v[52:55], v[30:31], v[82:83], v[52:55]
v_mfma_f32_16x16x16_bf16 v[48:51], v[32:33], v[84:85], v[48:51]
v_mfma_f32_16x16x16_bf16 v[52:55], v[32:33], v[86:87], v[52:55]
v_mfma_f32_16x16x16_bf16 v[48:51], v[34:35], v[88:89], v[48:51]
v_mfma_f32_16x16x16_bf16 v[52:55], v[34:35], v[90:91], v[52:55]
v_mfma_f32_16x16x16_bf16 v[48:51], v[36:37], v[92:93], v[48:51]
v_mfma_f32_16x16x16_bf16 v[52:55], v[36:37], v[94:95], v[52:55]
v_and_b32_dpp v30, v56, v60 quad_perm:[2,2,2,2] row_mask:0xf bank_mask:0xf
v_and_b32_dpp v31, v56, v61 quad_perm:[2,2,2,2] row_mask:0xf bank_mask:0xf
v_and_b32_dpp v32, v57, v60 quad_perm:[2,2,2,2] row_mask:0xf bank_mask:0xf
v_and_b32_dpp v33, v57, v61 quad_perm:[2,2,2,2] row_mask:0xf bank_mask:0xf
v_and_b32_dpp v34, v58, v60 quad_perm:[2,2,2,2] row_mask:0xf bank_mask:0xf
v_and_b32_dpp v35, v58, v61 quad_perm:[2,2,2,2] row_mask:0xf bank_mask:0xf
v_and_b32_dpp v36, v59, v60 quad_perm:[2,2,2,2] row_mask:0xf bank_mask:0xf
v_and_b32_dpp v37, v59, v61 quad_perm:[2,2,2,2] row_mask:0xf bank_mask:0xf
s_waitcnt vmcnt(4)
s_nop 0
v_mfma_f32_16x16x16_bf16 v[48:51], v[30:31], v[96:97], v[48:51]
v_mfma_f32_16x16x16_bf16 v[52:55], v[30:31], v[98:99], v[52:55]
v_mfma_f32_16x16x16_bf16 v[48:51], v[32:33], v[100:101], v[48:51]
v_mfma_f32_16x16x16_bf16 v[52:55], v[32:33], v[102:103], v[52:55]
v_mfma_f32_16x16x16_bf16 v[48:51], v[34:35], v[104:105], v[48:51]
v_mfma_f32_16x16x16_bf16 v[52:55], v[34:35], v[106:107], v[52:55]
v_mfma_f32_16x16x16_bf16 v[48:51], v[36:37], v[108:109], v[48:51]
v_mfma_f32_16x16x16_bf16 v[52:55], v[36:37], v[110:111], v[52:55]
s_nop 1
v_add_f32_dpp v47, v47, v47 quad_perm:[1,0,3,2] row_mask:0xf bank_mask:0xf
s_nop 1
v_add_f32_dpp v47, v47, v47 quad_perm:[2,3,0,1] row_mask:0xf bank_mask:0xf
v_mov_b32 v62, v47
s_nop 1
v_permlane16_swap_b32 v47, v62
s_nop 1
v_add_f32 v47, v47, v62
v_mov_b32 v62, v47
s_nop 1
v_permlane32_swap_b32 v47, v62
s_nop 1
v_add_f32 v47, v47, v62
s_lshl_b32 s45, s46, 11
s_add_u32 s45, s45, 1024
v_lshlrev_b32 v28, 5, v0
v_add_u32 v28, s45, v28
s_lshl_b32 s45, s46, 5
s_add_u32 s45, s45, 13312
v_bfe_u32 v29, v0, 2, 2
v_lshlrev_b32 v29, 3, v29
v_add_u32 v29, s45, v29
ds_write_b64 v29, v[46:47]
v_and_b32_dpp v30, v56, v60 quad_perm:[3,3,3,3] row_mask:0xf bank_mask:0xf
v_and_b32_dpp v31, v56, v61 quad_perm:[3,3,3,3] row_mask:0xf bank_mask:0xf
v_and_b32_dpp v32, v57, v60 quad_perm:[3,3,3,3] row_mask:0xf bank_mask:0xf
v_and_b32_dpp v33, v57, v61 quad_perm:[3,3,3,3] row_mask:0xf bank_mask:0xf
v_and_b32_dpp v34, v58, v60 quad_perm:[3,3,3,3] row_mask:0xf bank_mask:0xf
v_and_b32_dpp v35, v58, v61 quad_perm:[3,3,3,3] row_mask:0xf bank_mask:0xf
v_and_b32_dpp v36, v59, v60 quad_perm:[3,3,3,3] row_mask:0xf bank_mask:0xf
v_and_b32_dpp v37, v59, v61 quad_perm:[3,3,3,3] row_mask:0xf bank_mask:0xf
s_waitcnt vmcnt(0)
s_nop 0
v_mfma_f32_16x16x16_bf16 v[48:51], v[30:31], v[112:113], v[48:51]
v_mfma_f32_16x16x16_bf16 v[52:55], v[30:31], v[114:115], v[52:55]
v_mfma_f32_16x16x16_bf16 v[48:51], v[32:33], v[116:117], v[48:51]
v_mfma_f32_16x16x16_bf16 v[52:55], v[32:33], v[118:119], v[52:55]
v_mfma_f32_16x16x16_bf16 v[48:51], v[34:35], v[120:121], v[48:51]
v_mfma_f32_16x16x16_bf16 v[52:55], v[34:35], v[122:123], v[52:55]
v_mfma_f32_16x16x16_bf16 v[48:51], v[36:37], v[124:125], v[48:51]
v_mfma_f32_16x16x16_bf16 v[52:55], v[36:37], v[126:127], v[52:55]
s_nop 6
ds_write_b128 v28, v[48:51]
ds_write_b128 v28, v[52:55] offset:16
s_mov_b32 s36, s4
s_and_b32 s37, s5, 0xffff
s_mov_b32 s38, 0x400
s_mov_b32 s39, 0x20000
s_mov_b32 s44, s28
s_and_b32 s45, s29, 0xffff
s_mov_b32 s46, 0x20000000
s_mov_b32 s47, 0x20000
s_branch L_pref
L_hq:
s_setprio 3
v_lshlrev_b32 v1, 4, v0
v_and_b32 v2, 15, v0
v_lshrrev_b32 v3, 4, v0
s_lshr_b32 s99, s32, 2
s_waitcnt lgkmcnt(0)
s_load_dwordx2 s[96:97], s[28:29], 0x40000
s_mov_b32 s0, s99
s_and_b32 s1, s32, 3
s_mov_b32 s36, s4
s_and_b32 s37, s5, 0xffff
s_mov_b32 s38, 0x400
s_mov_b32 s39, 0x20000
s_mov_b32 s40, s10
s_and_b32 s41, s11, 0xffff
s_mov_b32 s42, 0x400000
s_mov_b32 s43, 0x20000
s_cmp_lg_u32 s33, 0
s_cbranch_scc1 L_h_b0
v_lshlrev_b32 v4, 17, v3
v_lshl_add_u32 v4, v2, 4, v4
s_lshl_b32 s14, s0, 19
s_lshl_b32 s15, s31, 2
s_add_u32 s15, s15, s1
s_lshl_b32 s15, s15, 8
s_add_u32 s14, s14, s15
buffer_load_dwordx4 v[8:11], v1, s[36:39], 0 offen
v_lshlrev_b32 v6, 5, v3
s_lshl_b32 s15, s0, 7
buffer_load_dwordx4 v[12:15], v6, s[36:39], s15 offen
buffer_load_dwordx4 v[16:19], v6, s[36:39], s15 offen offset:16
v_mov_b32 v5, 0
buffer_load_dword v20, v5, s[36:39], 0 offen
buffer_load_dwordx4 v[64:67], v4, s[40:43], s14 offen nt
s_add_u32 s14, s14, 8192
buffer_load_dwordx4 v[68:71], v4, s[40:43], s14 offen nt
s_add_u32 s14, s14, 8192
buffer_load_dwordx4 v[72:75], v4, s[40:43], s14 offen nt
s_add_u32 s14, s14, 8192
buffer_load_dwordx4 v[76:79], v4, s[40:43], s14 offen nt
s_add_u32 s14, s14, 8192
buffer_load_dwordx4 v[80:83], v4, s[40:43], s14 offen nt
s_add_u32 s14, s14, 8192
buffer_load_dwordx4 v[84:87], v4, s[40:43], s14 offen nt
s_add_u32 s14, s14, 8192
buffer_load_dwordx4 v[88:91], v4, s[40:43], s14 offen nt
s_add_u32 s14, s14, 8192
buffer_load_dwordx4 v[92:95], v4, s[40:43], s14 offen nt
s_add_u32 s14, s14, 8192
buffer_load_dwordx4 v[96:99], v4, s[40:43], s14 offen nt
s_add_u32 s14, s14, 8192
buffer_load_dwordx4 v[100:103], v4, s[40:43], s14 offen nt
s_add_u32 s14, s14, 8192
buffer_load_dwordx4 v[104:107], v4, s[40:43], s14 offen nt
s_add_u32 s14, s14, 8192
buffer_load_dwordx4 v[108:111], v4, s[40:43], s14 offen nt
s_add_u32 s14, s14, 8192
buffer_load_dwordx4 v[112:115], v4, s[40:43], s14 offen nt
s_add_u32 s14, s14, 8192
buffer_load_dwordx4 v[116:119], v4, s[40:43], s14 offen nt
s_add_u32 s14, s14, 8192
buffer_load_dwordx4 v[120:123], v4, s[40:43], s14 offen nt
s_add_u32 s14, s14, 8192
buffer_load_dwordx4 v[124:127], v4, s[40:43], s14 offen nt
s_add_u32 s14, s14, 8192
v_mov_b32 v7, 16704
ds_write_b32 v7, v5
ds_write_b32 v7, v5 offset:4
s_waitcnt lgkmcnt(0)
L_h_b0:
s_barrier
s_mov_b32 s44, s28
s_and_b32 s45, s29, 0xffff
s_mov_b32 s46, 0x20000000
s_mov_b32 s47, 0x20000
s_waitcnt lgkmcnt(0)
s_add_u32 s96, s96, 0x7f4a7c15
s_addc_u32 s97, s97, 0x9e3779b9
s_cmp_lg_u32 s33, 0
s_cbranch_scc1 L_h_qgather
v_and_b32 v4, 1, v0
v_lshlrev_b32 v4, 4, v4
v_mov_b32 v5, 0xffff
v_lshlrev_b32 v5, v4, v5
v_and_b32 v4, 2, v0
v_cmp_eq_u32 vcc, 0, v4
v_mov_b32 v6, 0
s_nop 0
v_cndmask_b32 v44, v6, v5, vcc
v_cndmask_b32 v45, v5, v6, vcc
v_lshlrev_b32 v46, 6, v2
v_lshl_add_u32 v46, v3, 4, v46
s_lshl_b32 s6, s31, 15
s_lshl_b32 s15, s0, 12
s_add_u32 s6, s6, s15
s_lshl_b32 s15, s1, 10
s_add_u32 s6, s6, s15
v_and_b32 v5, 1, v3
v_cmp_eq_u32 s[72:73], 1, v5
v_cmp_lt_u32 s[74:75], 1, v3
v_mov_b32 v26, s96
v_mov_b32 v27, s97
s_waitcnt vmcnt(16)
v_lshlrev_b32 v28, 16, v8
v_and_b32 v29, 0xffff0000, v8
v_lshlrev_b32 v30, 16, v9
v_and_b32 v31, 0xffff0000, v9
v_lshlrev_b32 v32, 16, v10
v_and_b32 v33, 0xffff0000, v10
v_lshlrev_b32 v34, 16, v11
v_and_b32 v35, 0xffff0000, v11
v_lshlrev_b32 v20, 16, v20
v_mov_b32 v21, v20
v_pk_add_f32 v[48:49], v[28:29], v[20:21] neg_lo:[0,1] neg_hi:[0,1]
v_pk_add_f32 v[50:51], v[30:31], v[20:21] neg_lo:[0,1] neg_hi:[0,1]
v_pk_add_f32 v[52:53], v[32:33], v[20:21] neg_lo:[0,1] neg_hi:[0,1]
v_pk_add_f32 v[54:55], v[34:35], v[20:21] neg_lo:[0,1] neg_hi:[0,1]
v_pk_mul_f32 v[56:57], v[48:49], v[48:49]
v_pk_fma_f32 v[56:57], v[50:51], v[50:51], v[56:57]
v_pk_fma_f32 v[56:57], v[52:53], v[52:53], v[56:57]
v_pk_fma_f32 v[56:57], v[54:55], v[54:55], v[56:57]
v_pk_add_f32 v[48:49], v[48:49], v[50:51]
v_pk_add_f32 v[52:53], v[52:53], v[54:55]
v_add_f32 v57, v56, v57
v_pk_add_f32 v[48:49], v[48:49], v[52:53]
v_add_f32 v56, v48, v49
s_nop 0
v_add_f32_dpp v57, v57, v57 quad_perm:[1,0,3,2] row_mask:0xf bank_mask:0xf
v_add_f32_dpp v56, v56, v56 quad_perm:[1,0,3,2] row_mask:0xf bank_mask:0xf
s_nop 0
v_add_f32_dpp v57, v57, v57 quad_perm:[2,3,0,1] row_mask:0xf bank_mask:0xf
v_add_f32_dpp v56, v56, v56 quad_perm:[2,3,0,1] row_mask:0xf bank_mask:0xf
s_nop 0
v_add_f32_dpp v57, v57, v57 row_half_mirror row_mask:0xf bank_mask:0xf
v_add_f32_dpp v56, v56, v56 row_half_mirror row_mask:0xf bank_mask:0xf
s_nop 0
v_add_f32_dpp v57, v57, v57 row_mirror row_mask:0xf bank_mask:0xf
v_add_f32_dpp v56, v56, v56 row_mirror row_mask:0xf bank_mask:0xf
s_nop 0
v_add_f32_dpp v57, v57, v57 row_bcast:15 row_mask:0xa bank_mask:0xf
v_add_f32_dpp v56, v56, v56 row_bcast:15 row_mask:0xa bank_mask:0xf
s_nop 0
v_add_f32_dpp v57, v57, v57 row_bcast:31 row_mask:0xc bank_mask:0xf
v_add_f32_dpp v56, v56, v56 row_bcast:31 row_mask:0xc bank_mask:0xf
s_nop 0
v_readlane_b32 s77, v57, 63
v_readlane_b32 s76, v56, 63
s_nop 1
v_mov_b32 v56, 0x3b000000
v_mul_f32 v57, s77, v56
v_mul_f32 v56, s76, v56
v_fma_f32 v57, -v56, v56, v57
v_max_f32 v57, 0, v57
v_add_f32 v56, v56, v20
v_cvt_pk_bf16_f32 v24, v56, v57
v_lshlrev_b32 v22, 16, v24
v_and_b32 v23, 0xffff0000, v24
v_add_f32 v23, 0x3727c5ac, v23
v_cvt_pk_bf16_f32 v23, v23, v23
v_lshlrev_b32 v23, 16, v23
v_sqrt_f32 v23, v23
s_nop 0
v_cvt_pk_bf16_f32 v23, v23, v23
v_lshlrev_b32 v23, 16, v23
v_rcp_f32 v23, v23
s_nop 0
v_lshlrev_b32 v28, 16, v12
v_and_b32 v29, 0xffff0000, v12
v_lshlrev_b32 v30, 16, v13
v_and_b32 v31, 0xffff0000, v13
v_lshlrev_b32 v32, 16, v14
v_and_b32 v33, 0xffff0000, v14
v_lshlrev_b32 v34, 16, v15
v_and_b32 v35, 0xffff0000, v15
v_lshlrev_b32 v36, 16, v16
v_and_b32 v37, 0xffff0000, v16
v_lshlrev_b32 v38, 16, v17
v_and_b32 v39, 0xffff0000, v17
v_lshlrev_b32 v40, 16, v18
v_and_b32 v41, 0xffff0000, v18
v_lshlrev_b32 v42, 16, v19
v_and_b32 v43, 0xffff0000, v19
v_sub_f32 v28, v28, v22
v_sub_f32 v29, v29, v22
v_cvt_pk_bf16_f32 v24, v28, v29
v_lshlrev_b32 v28, 16, v24
v_and_b32 v29, 0xffff0000, v24
v_mul_f32 v28, v28, v23
v_mul_f32 v29, v29, v23
v_cvt_pk_bf16_f32 v24, v28, v29
v_lshlrev_b32 v28, 16, v24
v_and_b32 v29, 0xffff0000, v24
v_sub_f32 v30, v30, v22
v_sub_f32 v31, v31, v22
v_cvt_pk_bf16_f32 v24, v30, v31
v_lshlrev_b32 v30, 16, v24
v_and_b32 v31, 0xffff0000, v24
v_mul_f32 v30, v30, v23
v_mul_f32 v31, v31, v23
v_cvt_pk_bf16_f32 v24, v30, v31
v_lshlrev_b32 v30, 16, v24
v_and_b32 v31, 0xffff0000, v24
v_sub_f32 v32, v32, v22
v_sub_f32 v33, v33, v22
v_cvt_pk_bf16_f32 v24, v32, v33
v_lshlrev_b32 v32, 16, v24
v_and_b32 v33, 0xffff0000, v24
v_mul_f32 v32, v32, v23
v_mul_f32 v33, v33, v23
v_cvt_pk_bf16_f32 v24, v32, v33
v_lshlrev_b32 v32, 16, v24
v_and_b32 v33, 0xffff0000, v24
v_sub_f32 v34, v34, v22
v_sub_f32 v35, v35, v22
v_cvt_pk_bf16_f32 v24, v34, v35
v_lshlrev_b32 v34, 16, v24
v_and_b32 v35, 0xffff0000, v24
v_mul_f32 v34, v34, v23
v_mul_f32 v35, v35, v23
v_cvt_pk_bf16_f32 v24, v34, v35
v_lshlrev_b32 v34, 16, v24
v_and_b32 v35, 0xffff0000, v24
v_sub_f32 v36, v36, v22
v_sub_f32 v37, v37, v22
v_cvt_pk_bf16_f32 v24, v36, v37
v_lshlrev_b32 v36, 16, v24
v_and_b32 v37, 0xffff0000, v24
v_mul_f32 v36, v36, v23
v_mul_f32 v37, v37, v23
v_cvt_pk_bf16_f32 v24, v36, v37
v_lshlrev_b32 v36, 16, v24
v_and_b32 v37, 0xffff0000, v24
v_sub_f32 v38, v38, v22
v_sub_f32 v39, v39, v22
v_cvt_pk_bf16_f32 v24, v38, v39
v_lshlrev_b32 v38, 16, v24
v_and_b32 v39, 0xffff0000, v24
v_mul_f32 v38, v38, v23
v_mul_f32 v39, v39, v23
v_cvt_pk_bf16_f32 v24, v38, v39
v_lshlrev_b32 v38, 16, v24
v_and_b32 v39, 0xffff0000, v24
v_sub_f32 v40, v40, v22
v_sub_f32 v41, v41, v22
v_cvt_pk_bf16_f32 v24, v40, v41
v_lshlrev_b32 v40, 16, v24
v_and_b32 v41, 0xffff0000, v24
v_mul_f32 v40, v40, v23
v_mul_f32 v41, v41, v23
v_cvt_pk_bf16_f32 v24, v40, v41
v_lshlrev_b32 v40, 16, v24
v_and_b32 v41, 0xffff0000, v24
v_sub_f32 v42, v42, v22
v_sub_f32 v43, v43, v22
v_cvt_pk_bf16_f32 v24, v42, v43
v_lshlrev_b32 v42, 16, v24
v_and_b32 v43, 0xffff0000, v24
v_mul_f32 v42, v42, v23
v_mul_f32 v43, v43, v23
v_cvt_pk_bf16_f32 v24, v42, v43
v_lshlrev_b32 v42, 16, v24
v_and_b32 v43, 0xffff0000, v24
v_cvt_pk_bf16_f32 v24, v28, v28
v_and_b32 v56, v24, v44
v_and_b32 v57, v24, v45
s_waitcnt vmcnt(15)
s_nop 0
v_mfma_f32_16x16x16_bf16 v[48:51], v[56:57], v[64:65], 0
v_mfma_f32_16x16x16_bf16 v[52:55], v[56:57], v[66:67], 0
v_cvt_pk_bf16_f32 v24, v29, v29
v_and_b32 v58, v24, v44
v_and_b32 v59, v24, v45
s_waitcnt vmcnt(14)
s_nop 0
v_mfma_f32_16x16x16_bf16 v[48:51], v[58:59], v[68:69], v[48:51]
v_mfma_f32_16x16x16_bf16 v[52:55], v[58:59], v[70:71], v[52:55]
v_cvt_pk_bf16_f32 v24, v30, v30
v_and_b32 v60, v24, v44
v_and_b32 v61, v24, v45
s_waitcnt vmcnt(13)
s_nop 0
v_mfma_f32_16x16x16_bf16 v[48:51], v[60:61], v[72:73], v[48:51]
v_mfma_f32_16x16x16_bf16 v[52:55], v[60:61], v[74:75], v[52:55]
v_cvt_pk_bf16_f32 v24, v31, v31
v_and_b32 v62, v24, v44
v_and_b32 v63, v24, v45
s_waitcnt vmcnt(12)
s_nop 0
v_mfma_f32_16x16x16_bf16 v[48:51], v[62:63], v[76:77], v[48:51]
v_mfma_f32_16x16x16_bf16 v[52:55], v[62:63], v[78:79], v[52:55]
v_cvt_pk_bf16_f32 v24, v32, v32
v_and_b32 v56, v24, v44
v_and_b32 v57, v24, v45
s_waitcnt vmcnt(11)
s_nop 0
v_mfma_f32_16x16x16_bf16 v[48:51], v[56:57], v[80:81], v[48:51]
v_mfma_f32_16x16x16_bf16 v[52:55], v[56:57], v[82:83], v[52:55]
v_cvt_pk_bf16_f32 v24, v33, v33
v_and_b32 v58, v24, v44
v_and_b32 v59, v24, v45
s_waitcnt vmcnt(10)
s_nop 0
v_mfma_f32_16x16x16_bf16 v[48:51], v[58:59], v[84:85], v[48:51]
v_mfma_f32_16x16x16_bf16 v[52:55], v[58:59], v[86:87], v[52:55]
v_cvt_pk_bf16_f32 v24, v34, v34
v_and_b32 v60, v24, v44
v_and_b32 v61, v24, v45
s_waitcnt vmcnt(9)
s_nop 0
v_mfma_f32_16x16x16_bf16 v[48:51], v[60:61], v[88:89], v[48:51]
v_mfma_f32_16x16x16_bf16 v[52:55], v[60:61], v[90:91], v[52:55]
v_cvt_pk_bf16_f32 v24, v35, v35
v_and_b32 v62, v24, v44
v_and_b32 v63, v24, v45
s_waitcnt vmcnt(8)
s_nop 0
v_mfma_f32_16x16x16_bf16 v[48:51], v[62:63], v[92:93], v[48:51]
v_mfma_f32_16x16x16_bf16 v[52:55], v[62:63], v[94:95], v[52:55]
v_cvt_pk_bf16_f32 v24, v36, v36
v_and_b32 v56, v24, v44
v_and_b32 v57, v24, v45
s_waitcnt vmcnt(7)
s_nop 0
v_mfma_f32_16x16x16_bf16 v[48:51], v[56:57], v[96:97], v[48:51]
v_mfma_f32_16x16x16_bf16 v[52:55], v[56:57], v[98:99], v[52:55]
v_cvt_pk_bf16_f32 v24, v37, v37
v_and_b32 v58, v24, v44
v_and_b32 v59, v24, v45
s_waitcnt vmcnt(6)
s_nop 0
v_mfma_f32_16x16x16_bf16 v[48:51], v[58:59], v[100:101], v[48:51]
v_mfma_f32_16x16x16_bf16 v[52:55], v[58:59], v[102:103], v[52:55]
v_cvt_pk_bf16_f32 v24, v38, v38
v_and_b32 v60, v24, v44
v_and_b32 v61, v24, v45
s_waitcnt vmcnt(5)
s_nop 0
v_mfma_f32_16x16x16_bf16 v[48:51], v[60:61], v[104:105], v[48:51]
v_mfma_f32_16x16x16_bf16 v[52:55], v[60:61], v[106:107], v[52:55]
v_cvt_pk_bf16_f32 v24, v39, v39
v_and_b32 v62, v24, v44
v_and_b32 v63, v24, v45
s_waitcnt vmcnt(4)
s_nop 0
v_mfma_f32_16x16x16_bf16 v[48:51], v[62:63], v[108:109], v[48:51]
v_mfma_f32_16x16x16_bf16 v[52:55], v[62:63], v[110:111], v[52:55]
v_cvt_pk_bf16_f32 v24, v40, v40
v_and_b32 v56, v24, v44
v_and_b32 v57, v24, v45
s_waitcnt vmcnt(3)
s_nop 0
v_mfma_f32_16x16x16_bf16 v[48:51], v[56:57], v[112:113], v[48:51]
v_mfma_f32_16x16x16_bf16 v[52:55], v[56:57], v[114:115], v[52:55]
v_cvt_pk_bf16_f32 v24, v41, v41
v_and_b32 v58, v24, v44
v_and_b32 v59, v24, v45
s_waitcnt vmcnt(2)
s_nop 0
v_mfma_f32_16x16x16_bf16 v[48:51], v[58:59], v[116:117], v[48:51]
v_mfma_f32_16x16x16_bf16 v[52:55], v[58:59], v[118:119], v[52:55]
v_cvt_pk_bf16_f32 v24, v42, v42
v_and_b32 v60, v24, v44
v_and_b32 v61, v24, v45
s_waitcnt vmcnt(1)
s_nop 0
v_mfma_f32_16x16x16_bf16 v[48:51], v[60:61], v[120:121], v[48:51]
v_mfma_f32_16x16x16_bf16 v[52:55], v[60:61], v[122:123], v[52:55]
v_cvt_pk_bf16_f32 v24, v43, v43
v_and_b32 v62, v24, v44
v_and_b32 v63, v24, v45
s_waitcnt vmcnt(0)
s_nop 0
v_mfma_f32_16x16x16_bf16 v[48:51], v[62:63], v[124:125], v[48:51]
v_mfma_f32_16x16x16_bf16 v[52:55], v[62:63], v[126:127], v[52:55]
s_nop 7
v_cndmask_b32 v48, v48, v52, s[74:75]
v_cndmask_b32 v49, v49, v53, s[74:75]
v_cndmask_b32 v50, v50, v54, s[74:75]
v_cndmask_b32 v51, v51, v55, s[74:75]
v_cndmask_b32 v24, v48, v50, s[72:73]
v_cndmask_b32 v25, v49, v51, s[72:73]
buffer_store_dwordx4 v[24:27], v46, s[44:47], s6 offen offset:0 sc1
v_lshlrev_b32 v5, 10, v0
s_lshl_b32 s14, s31, 15
s_mov_b32 exec_hi, 0
s_mov_b32 s15, 200000
L_probe_10:
s_sleep 8
buffer_load_dwordx2 v[28:29], v5, s[44:47], s14 offen offset:1016 sc1
s_sub_u32 s15, s15, 1
s_cmp_eq_u32 s15, 0
s_cbranch_scc1 L_probe_10_x
s_waitcnt vmcnt(0)
v_cmp_ne_u64 vcc, s[96:97], v[28:29]
s_and_b64 exec, exec, vcc
s_cbranch_execnz L_probe_10
L_probe_10_x:
s_mov_b64 exec, -1
v_mov_b32 v6, 1
ds_write_b32 v7, v6
L_h_qgather:
v_mov_b32 v7, 16704
s_lshl_b32 s14, s31, 15
s_lshl_b32 s15, s33, 11
s_add_u32 s14, s14, s15
s_mov_b32 s15, 4000000
L_ldsw_11:
ds_read_b32 v11, v7 offset:0
s_sub_u32 s15, s15, 1
s_cmp_eq_u32 s15, 0
s_cbranch_scc1 L_ldsw_11_x
s_waitcnt lgkmcnt(0)
v_cmp_eq_u32 vcc, 0, v11
s_cbranch_vccz L_ldsw_11_x
s_sleep 1
s_branch L_ldsw_11
L_ldsw_11_x:
s_waitcnt lgkmcnt(0)
s_mov_b32 s15, 200000
L_pollqd_12:
s_mov_b32 s8, s14
L_pollqd_12_f:
buffer_load_dwordx4 v[64:67], v1, s[44:47], s8 offen offset:0 sc1
buffer_load_dwordx4 v[68:71], v1, s[44:47], s8 offen offset:1024 sc1
s_add_u32 s8, s8, 4096
buffer_load_dwordx4 v[72:75], v1, s[44:47], s8 offen offset:0 sc1
buffer_load_dwordx4 v[76:79], v1, s[44:47], s8 offen offset:1024 sc1
s_add_u32 s8, s8, 4096
buffer_load_dwordx4 v[80:83], v1, s[44:47], s8 offen offset:0 sc1
buffer_load_dwordx4 v[84:87], v1, s[44:47], s8 offen offset:1024 sc1
s_add_u32 s8, s8, 4096
buffer_load_dwordx4 v[88:91], v1, s[44:47], s8 offen offset:0 sc1
buffer_load_dwordx4 v[92:95], v1, s[44:47], s8 offen offset:1024 sc1
s_add_u32 s8, s8, 4096
buffer_load_dwordx4 v[96:99], v1, s[44:47], s8 offen offset:0 sc1
buffer_load_dwordx4 v[100:103], v1, s[44:47], s8 offen offset:1024 sc1
s_add_u32 s8, s8, 4096
buffer_load_dwordx4 v[104:107], v1, s[44:47], s8 offen offset:0 sc1
buffer_load_dwordx4 v[108:111], v1, s[44:47], s8 offen offset:1024 sc1
s_add_u32 s8, s8, 4096
buffer_load_dwordx4 v[112:115], v1, s[44:47], s8 offen offset:0 sc1
buffer_load_dwordx4 v[116:119], v1, s[44:47], s8 offen offset:1024 sc1
s_add_u32 s8, s8, 4096
buffer_load_dwordx4 v[120:123], v1, s[44:47], s8 offen offset:0 sc1
buffer_load_dwordx4 v[124:127], v1, s[44:47], s8 offen offset:1024 sc1
s_sub_u32 s15, s15, 1
s_cmp_eq_u32 s15, 0
s_cbranch_scc1 L_pollqd_12_x
s_waitcnt vmcnt(15)
v_cmp_ne_u64 s[76:77], s[96:97], v[66:67]
s_waitcnt vmcnt(14)
v_cmp_ne_u64 vcc, s[96:97], v[70:71]
s_or_b64 s[76:77], s[76:77], vcc
s_waitcnt vmcnt(13)
v_cmp_ne_u64 vcc, s[96:97], v[74:75]
s_or_b64 s[76:77], s[76:77], vcc
s_waitcnt vmcnt(12)
v_cmp_ne_u64 vcc, s[96:97], v[78:79]
s_or_b64 s[76:77], s[76:77], vcc
s_waitcnt vmcnt(11)
v_cmp_ne_u64 vcc, s[96:97], v[82:83]
s_or_b64 s[76:77], s[76:77], vcc
s_waitcnt vmcnt(10)
v_cmp_ne_u64 vcc, s[96:97], v[86:87]
s_or_b64 s[76:77], s[76:77], vcc
s_waitcnt vmcnt(9)
v_cmp_ne_u64 vcc, s[96:97], v[90:91]
s_or_b64 s[76:77], s[76:77], vcc
s_waitcnt vmcnt(8)
v_cmp_ne_u64 vcc, s[96:97], v[94:95]
s_or_b64 s[76:77], s[76:77], vcc
s_waitcnt vmcnt(7)
v_cmp_ne_u64 vcc, s[96:97], v[98:99]
s_or_b64 s[76:77], s[76:77], vcc
s_waitcnt vmcnt(6)
v_cmp_ne_u64 vcc, s[96:97], v[102:103]
s_or_b64 s[76:77], s[76:77], vcc
s_waitcnt vmcnt(5)
v_cmp_ne_u64 vcc, s[96:97], v[106:107]
s_or_b64 s[76:77], s[76:77], vcc
s_waitcnt vmcnt(4)
v_cmp_ne_u64 vcc, s[96:97], v[110:111]
s_or_b64 s[76:77], s[76:77], vcc
s_waitcnt vmcnt(3)
v_cmp_ne_u64 vcc, s[96:97], v[114:115]
s_or_b64 s[76:77], s[76:77], vcc
s_waitcnt vmcnt(2)
v_cmp_ne_u64 vcc, s[96:97], v[118:119]
s_or_b64 s[76:77], s[76:77], vcc
s_waitcnt vmcnt(1)
v_cmp_ne_u64 vcc, s[96:97], v[122:123]
s_or_b64 s[76:77], s[76:77], vcc
s_waitcnt vmcnt(0)
v_cmp_ne_u64 vcc, s[96:97], v[126:127]
s_or_b64 s[76:77], s[76:77], vcc
s_and_b64 exec, exec, s[76:77]
s_cbranch_execz L_pollqd_12_x
s_sleep 2
s_branch L_pollqd_12
L_pollqd_12_x:
s_mov_b64 exec, -1
s_waitcnt vmcnt(0)
v_pk_add_f32 v[64:65], v[64:65], v[72:73]
v_pk_add_f32 v[68:69], v[68:69], v[76:77]
v_pk_add_f32 v[64:65], v[64:65], v[80:81]
v_pk_add_f32 v[68:69], v[68:69], v[84:85]
v_pk_add_f32 v[64:65], v[64:65], v[88:89]
v_pk_add_f32 v[68:69], v[68:69], v[92:93]
v_pk_add_f32 v[64:65], v[64:65], v[96:97]
v_pk_add_f32 v[68:69], v[68:69], v[100:101]
v_pk_add_f32 v[64:65], v[64:65], v[104:105]
v_pk_add_f32 v[68:69], v[68:69], v[108:109]
v_pk_add_f32 v[64:65], v[64:65], v[112:113]
v_pk_add_f32 v[68:69], v[68:69], v[116:117]
v_pk_add_f32 v[64:65], v[64:65], v[120:121]
v_pk_add_f32 v[68:69], v[68:69], v[124:125]
v_cvt_pk_bf16_f32 v16, v64, v65
v_cvt_pk_bf16_f32 v17, v68, v69
s_lshl_b32 s15, s33, 9
v_lshl_add_u32 v5, v0, 2, s15
ds_write_b32 v5, v16 offset:0
ds_write_b32 v5, v17 offset:256
s_waitcnt lgkmcnt(0)
s_barrier
s_cmp_lg_u32 s33, 1
s_cbranch_scc1 L_pref
v_mov_b32 v24, -1
v_mov_b32 v25, -1
v_mov_b32 v26, -1
v_mov_b32 v27, -1
s_lshl_b32 s14, s3, 11
s_add_u32 s14, s14, 0x42000
buffer_store_dwordx4 v[24:27], v1, s[44:47], s14 offen offset:0 sc1
buffer_store_dwordx4 v[24:27], v1, s[44:47], s14 offen offset:1024 sc1
s_lshl_b32 s14, s31, 2
s_add_u32 s14, s14, s34
s_lshl_b32 s14, s14, 11
s_lshl_b32 s15, s35, 8
s_add_u32 s14, s14, s15
s_add_u32 s14, s14, 0x110000
v_lshlrev_b32 v5, 2, v0
buffer_store_dword v24, v5, s[44:47], s14 offen sc1
s_cmp_ge_u32 s32, 16
s_cbranch_scc1 L_h1_nohv
s_mul_i32 s14, s31, 2432
s_add_u32 s14, s14, 0x120000
s_lshl_b32 s15, s32, 7
v_add_u32 v5, s15, v1
s_lshl_b32 s15, s32, 4
s_add_u32 s15, s15, 2048
v_mov_b32 v6, s15
v_cmp_eq_u32 vcc, 8, v0
s_nop 1
v_cndmask_b32 v5, v5, v6, vcc
s_mov_b64 exec, 0x1ff
buffer_store_dwordx4 v[24:27], v5, s[44:47], s14 offen sc1
s_mov_b64 exec, -1
L_h1_nohv:
s_cmp_lg_u32 s32, 0
s_cbranch_scc1 L_h1_nocnt
s_lshl_b32 s14, s31, 10
s_add_u32 s14, s14, 0x128000
v_mov_b32 v32, 0
v_mov_b32 v33, 0
v_mov_b32 v34, 0
v_mov_b32 v35, 0
buffer_store_dwordx4 v[32:35], v1, s[44:47], s14 offen sc1
L_h1_nocnt:
s_getreg_b32 s8, hwreg(HW_REG_XCC_ID, 0, 4)
v_mov_b32 v28, s96
v_mov_b32 v29, s97
v_mov_b32 v30, s8
v_mov_b32 v31, 0
v_mov_b32 v5, 0
s_lshl_b32 s14, s3, 4
s_add_u32 s14, s14, 0x41000
s_mov_b64 exec, 1
s_waitcnt vmcnt(0)
buffer_store_dwordx4 v[28:31], v5, s[44:47], s14 offen sc1
s_mov_b64 exec, -1
s_mov_b32 s14, 0x41000
s_mov_b32 s15, 200000
L_pollall_13:
s_sleep 127
s_sleep 127
buffer_load_dwordx2 v[24:25], v1, s[44:47], s14 offen offset:0 sc1
buffer_load_dwordx2 v[26:27], v1, s[44:47], s14 offen offset:1024 sc1
buffer_load_dwordx2 v[28:29], v1, s[44:47], s14 offen offset:2048 sc1
buffer_load_dwordx2 v[30:31], v1, s[44:47], s14 offen offset:3072 sc1
s_sub_u32 s15, s15, 1
s_cmp_eq_u32 s15, 0
s_cbranch_scc1 L_pollall_13_x
s_waitcnt vmcnt(0)
v_cmp_ne_u64 s[76:77], s[96:97], v[24:25]
v_cmp_ne_u64 vcc, s[96:97], v[26:27]
s_or_b64 s[76:77], s[76:77], vcc
v_cmp_ne_u64 vcc, s[96:97], v[28:29]
s_or_b64 s[76:77], s[76:77], vcc
v_cmp_ne_u64 vcc, s[96:97], v[30:31]
s_or_b64 s[76:77], s[76:77], vcc
s_and_b64 exec, exec, s[76:77]
s_cbranch_execnz L_pollall_13
L_pollall_13_x:
s_mov_b64 exec, -1
v_mov_b32 v6, 1
ds_write_b32 v7, v6 offset:4
s_lshl_b32 s14, s31, 9
s_add_u32 s14, s14, 0x41000
s_mov_b32 exec_hi, 0
buffer_load_dwordx4 v[24:27], v1, s[44:47], s14 offen sc1
s_waitcnt vmcnt(0)
v_cmp_ne_u64 s[76:77], s[96:97], v[24:25]
v_cmp_ne_u32 vcc, s8, v26
s_or_b64 s[76:77], s[76:77], vcc
s_cselect_b32 s14, 0, 1
s_mov_b64 exec, -1
v_mov_b32 v6, s14
ds_write_b32 v7, v6 offset:8
L_pref:
s_setprio 3
s_mov_b32 s48, s12
s_and_b32 s49, s13, 0xffff
s_mov_b32 s50, 0x400000
s_mov_b32 s51, 0x20000
s_mov_b32 s52, s16
s_and_b32 s53, s17, 0xffff
s_mov_b32 s54, 0xe00
s_mov_b32 s55, 0x20000
s_mov_b32 s56, s18
s_and_b32 s57, s19, 0xffff
s_mov_b32 s58, 0xe00
s_mov_b32 s59, 0x20000
s_mov_b32 s60, s20
s_and_b32 s61, s21, 0xffff
s_mov_b32 s62, 0xe00
s_mov_b32 s63, 0x20000
s_mov_b32 s64, s22
s_and_b32 s65, s23, 0xffff
s_mov_b32 s66, 0x2
s_mov_b32 s67, 0x20000
s_mov_b32 s68, s24
s_and_b32 s69, s25, 0xffff
s_mov_b32 s70, 0x400
s_mov_b32 s71, 0x20000
s_mov_b32 s9, 0x3fb8aa3b
v_lshlrev_b32 v1, 4, v0
v_and_b32 v8, 7, v0
v_lshrrev_b32 v9, 3, v0
v_and_b32 v10, 31, v0
v_lshlrev_b32 v4, 12, v8
v_lshl_add_u32 v4, v9, 4, v4
s_lshl_b32 s8, s31, 2
s_add_u32 s8, s8, s34
s_lshl_b32 s14, s8, 17
s_lshl_b32 s15, s33, 15
s_add_u32 s14, s14, s15
s_lshl_b32 s15, s35, 7
s_add_u32 s14, s14, s15
buffer_load_dwordx4 v[64:67], v4, s[48:51], s14 offen offset:0 nt
buffer_load_dwordx4 v[68:71], v4, s[48:51], s14 offen offset:1024 nt
buffer_load_dwordx4 v[72:75], v4, s[48:51], s14 offen offset:2048 nt
buffer_load_dwordx4 v[76:79], v4, s[48:51], s14 offen offset:3072 nt
v_lshlrev_b32 v4, 3, v0
s_lshl_b32 s14, s30, 9
buffer_load_dwordx2 v[234:235], v4, s[52:55], s14 offen
buffer_load_dwordx2 v[236:237], v4, s[56:59], s14 offen
buffer_load_dwordx2 v[232:233], v4, s[60:63], s14 offen
v_lshlrev_b32 v5, 3, v8
s_and_b32 s14, s32, 15
s_lshl_b32 s14, s14, 6
buffer_load_dwordx2 v[108:109], v5, s[36:39], s14 offen
v_mov_b32 v5, 0
buffer_load_ushort v110, v5, s[64:67], 0 offen
s_lshl_b32 s14, s33, 9
s_add_u32 s14, s14, 1024
v_lshl_add_u32 v140, v10, 4, s14
s_lshl_b32 s14, s33, 3
s_add_u32 s14, s14, 13312
v_mov_b32 v141, s14
v_lshlrev_b32 v142, 11, v9
s_lshl_b32 s14, s33, 7
v_lshl_add_u32 v142, v8, 4, v142
v_add_u32 v142, s14, v142
s_lshl_b32 s14, s33, 8
s_add_u32 s14, s14, 13568
v_lshl_add_u32 v144, v9, 5, s14
v_lshlrev_b32 v145, 2, v0
v_lshlrev_b32 v4, 13, v9
v_lshl_add_u32 v146, v8, 4, v4
s_and_b32 s15, s32, 15
s_lshl_b32 s14, s15, 7
s_add_u32 s6, s14, 0x110000
s_add_u32 s7, s6, 4096
s_mul_i32 s25, s31, 2432
s_add_u32 s25, s25, 0x120000
v_add_u32 v148, s14, v1
s_lshl_b32 s15, s15, 4
s_add_u32 s15, s15, 2048
v_mov_b32 v4, s15
v_cmp_eq_u32 s[48:49], 8, v0
s_nop 1
v_cndmask_b32 v148, v148, v4, s[48:49]
s_lshr_b32 s14, s2, 1
s_lshl_b32 s14, s14, 4
v_mov_b32 v4, s14
v_add_u32 v147, 0x800, v1
v_cmp_lt_u32 vcc, 15, v0
v_mov_b32 v149, 14592
s_nop 0
v_cndmask_b32 v147, v147, v4, vcc
s_lshl_b32 s14, s3, 11
s_lshl_b32 s15, s33, 9
s_add_u32 s14, s14, s15
s_add_u32 s16, s14, 0x42000
s_lshl_b32 s14, s31, 16
s_lshl_b32 s15, s34, 9
s_add_u32 s14, s14, s15
s_add_u32 s10, s14, 0x42000
s_add_u32 s11, s10, 16384
s_add_u32 s12, s10, 32768
s_add_u32 s13, s10, 49152
s_lshl_b32 s14, s8, 11
s_lshl_b32 s15, s35, 8
s_add_u32 s14, s14, s15
s_add_u32 s17, s14, 0x110000
s_waitcnt vmcnt(0)
s_mov_b32 s14, 0x05040100
s_mov_b32 s15, 0x07060302
v_perm_b32 v80, v68, v64, s14
v_perm_b32 v81, v68, v64, s15
v_perm_b32 v82, v69, v65, s14
v_perm_b32 v83, v69, v65, s15
v_perm_b32 v84, v70, v66, s14
v_perm_b32 v85, v70, v66, s15
v_perm_b32 v86, v71, v67, s14
v_perm_b32 v87, v71, v67, s15
v_perm_b32 v88, v76, v72, s14
v_perm_b32 v89, v76, v72, s15
v_perm_b32 v90, v77, v73, s14
v_perm_b32 v91, v77, v73, s15
v_perm_b32 v92, v78, v74, s14
v_perm_b32 v93, v78, v74, s15
v_perm_b32 v94, v79, v75, s14
v_perm_b32 v95, v79, v75, s15
v_lshlrev_b32 v224, 16, v234
v_and_b32 v225, 0xffff0000, v234
v_lshlrev_b32 v228, 16, v236
v_and_b32 v229, 0xffff0000, v236
v_mov_b32 v238, 0xc0135761
v_mov_b32 v240, 0xbdd2d3e8
v_mov_b32 v242, 1.0
v_lshlrev_b32 v226, 16, v235
v_and_b32 v227, 0xffff0000, v235
v_lshlrev_b32 v230, 16, v237
v_and_b32 v231, 0xffff0000, v237
v_mov_b32 v239, 0xc0135761
v_mov_b32 v241, 0xbdd2d3e8
v_mov_b32 v243, 1.0
v_lshlrev_b32 v128, 16, v108
v_and_b32 v129, 0xffff0000, v108
v_lshlrev_b32 v130, 16, v109
v_and_b32 v131, 0xffff0000, v109
v_lshlrev_b32 v110, 16, v110
v_cmp_lt_u32 s[18:19], 31, v0
s_mov_b64 s[72:73], -1
s_mov_b64 s[74:75], -1
s_mov_b64 s[76:77], -1
s_mov_b64 s[78:79], -1
s_waitcnt lgkmcnt(0)
s_barrier
L_seg_a:
ds_read_b32 v14, v149 offset:2120
ds_read_b64 v[16:17], v141 offset:0
ds_read_b64 v[18:19], v141 offset:32
ds_read_b64 v[20:21], v141 offset:64
ds_read_b64 v[22:23], v141 offset:96
ds_read_b64 v[24:25], v141 offset:128
ds_read_b64 v[26:27], v141 offset:160
ds_read_b128 v[28:31], v140 offset:0
ds_read_b128 v[32:35], v140 offset:2048
ds_read_b128 v[36:39], v140 offset:4096
ds_read_b128 v[40:43], v140 offset:6144
ds_read_b128 v[44:47], v140 offset:8192
ds_read_b128 v[48:51], v140 offset:10240
s_waitcnt lgkmcnt(6)
v_max3_f32 v12, v16, v18, v20
v_max3_f32 v13, v22, v24, v26
v_max_f32 v12, v12, v13
v_readfirstlane_b32 s24, v14
v_mul_f32 v13, s9, v12
v_fma_f32 v16, v16, s9, -v13
v_fma_f32 v18, v18, s9, -v13
v_fma_f32 v20, v20, s9, -v13
v_fma_f32 v22, v22, s9, -v13
v_fma_f32 v24, v24, s9, -v13
v_fma_f32 v26, v26, s9, -v13
v_exp_f32 v16, v16
v_exp_f32 v18, v18
v_exp_f32 v20, v20
v_exp_f32 v22, v22
v_exp_f32 v24, v24
v_exp_f32 v26, v26
v_mul_f32 v13, v16, v17
v_fmac_f32 v13, v18, v19
v_fmac_f32 v13, v20, v21
v_fmac_f32 v13, v22, v23
v_fmac_f32 v13, v24, v25
v_fmac_f32 v13, v26, v27
s_waitcnt lgkmcnt(0)
v_mul_f32 v52, v16, v28
v_mul_f32 v53, v16, v29
v_mul_f32 v54, v16, v30
v_mul_f32 v55, v16, v31
v_fmac_f32 v52, v18, v32
v_fmac_f32 v53, v18, v33
v_fmac_f32 v54, v18, v34
v_fmac_f32 v55, v18, v35
v_fmac_f32 v52, v20, v36
v_fmac_f32 v53, v20, v37
v_fmac_f32 v54, v20, v38
v_fmac_f32 v55, v20, v39
v_fmac_f32 v52, v22, v40
v_fmac_f32 v53, v22, v41
v_fmac_f32 v54, v22, v42
v_fmac_f32 v55, v22, v43
v_fmac_f32 v52, v24, v44
v_fmac_f32 v53, v24, v45
v_fmac_f32 v54, v24, v46
v_fmac_f32 v55, v24, v47
v_fmac_f32 v52, v26, v48
v_fmac_f32 v53, v26, v49
v_fmac_f32 v54, v26, v50
v_fmac_f32 v55, v26, v51
v_cvt_pk_bf16_f32 v52, v52, v53
v_cvt_pk_bf16_f32 v53, v54, v55
v_min_u32 v54, 0xfffffffe, v12
v_min_u32 v55, 0xfffffffe, v13
v_min_u32 v52, 0xfffffffe, v52
v_min_u32 v53, 0xfffffffe, v53
s_mov_b32 exec_hi, 0
s_cmp_eq_u32 s24, 0
s_cbranch_scc1 L_st_14
buffer_store_dwordx4 v[52:55], v1, s[44:47], s16 offen
s_branch L_st_14_x
L_st_14:
buffer_store_dwordx4 v[52:55], v1, s[44:47], s16 offen sc1
L_st_14_x:
s_mov_b32 s15, 200000
L_poll1_15:
s_mov_b64 exec, s[72:73]
s_cbranch_execz L_poll1_15_l0
buffer_load_dwordx4 v[16:19], v142, s[44:47], s10 offen sc1
L_poll1_15_l0:
s_mov_b64 exec, s[74:75]
s_cbranch_execz L_poll1_15_l1
buffer_load_dwordx4 v[20:23], v142, s[44:47], s11 offen sc1
L_poll1_15_l1:
s_mov_b64 exec, s[76:77]
s_cbranch_execz L_poll1_15_l2
buffer_load_dwordx4 v[24:27], v142, s[44:47], s12 offen sc1
L_poll1_15_l2:
s_mov_b64 exec, s[78:79]
s_cbranch_execz L_poll1_15_l3
buffer_load_dwordx4 v[28:31], v142, s[44:47], s13 offen sc1
L_poll1_15_l3:
s_sub_u32 s15, s15, 1
s_cmp_eq_u32 s15, 0
s_cbranch_scc1 L_poll1_15_x
s_waitcnt vmcnt(0)
s_mov_b64 exec, s[72:73]
v_max3_u32 v12, v16, v17, v18
v_max_u32 v12, v12, v19
v_cmp_eq_u32 s[72:73], -1, v12
s_mov_b64 exec, s[74:75]
v_max3_u32 v12, v20, v21, v22
v_max_u32 v12, v12, v23
v_cmp_eq_u32 s[74:75], -1, v12
s_mov_b64 exec, s[76:77]
v_max3_u32 v12, v24, v25, v26
v_max_u32 v12, v12, v27
v_cmp_eq_u32 s[76:77], -1, v12
s_mov_b64 exec, s[78:79]
v_max3_u32 v12, v28, v29, v30
v_max_u32 v12, v12, v31
v_cmp_eq_u32 s[78:79], -1, v12
s_or_b64 s[20:21], s[72:73], s[74:75]
s_or_b64 vcc, s[76:77], s[78:79]
s_or_b64 s[20:21], s[20:21], vcc
s_cbranch_scc0 L_poll1_15_x
s_bcnt1_i32_b64 s14, s[20:21]
s_cmp_gt_u32 s14, 16
s_cbranch_scc1 L_poll1_15_s
s_branch L_poll1_15
L_poll1_15_s:
s_sleep 1
s_branch L_poll1_15
L_poll1_15_x:
s_mov_b64 exec, -1
s_waitcnt vmcnt(0)
L_seg_b:
v_max3_f32 v12, v18, v22, v26
v_max_f32 v12, v12, v30
v_lshlrev_b32 v32, 16, v16
v_and_b32 v33, 0xffff0000, v16
v_lshlrev_b32 v36, 16, v20
v_and_b32 v37, 0xffff0000, v20
v_max_f32_dpp v12, v12, v12 row_ror:8 row_mask:0xf bank_mask:0xf
v_mov_b32 v13, v12
v_lshlrev_b32 v34, 16, v17
v_and_b32 v35, 0xffff0000, v17
v_lshlrev_b32 v38, 16, v21
v_and_b32 v39, 0xffff0000, v21
v_permlane16_swap_b32 v12, v13
v_lshlrev_b32 v52, 16, v24
v_and_b32 v53, 0xffff0000, v24
v_lshlrev_b32 v56, 16, v28
v_and_b32 v57, 0xffff0000, v28
v_max_f32 v12, v12, v13
v_mov_b32 v13, v12
v_lshlrev_b32 v54, 16, v25
v_and_b32 v55, 0xffff0000, v25
v_lshlrev_b32 v58, 16, v29
v_and_b32 v59, 0xffff0000, v29
v_permlane32_swap_b32 v12, v13
s_nop 1
v_max_f32 v12, v12, v13
v_mul_f32 v12, s9, v12
v_fma_f32 v18, v18, s9, -v12
v_fma_f32 v22, v22, s9, -v12
v_fma_f32 v26, v26, s9, -v12
v_fma_f32 v30, v30, s9, -v12
v_exp_f32 v18, v18
v_exp_f32 v22, v22
v_exp_f32 v26, v26
v_exp_f32 v30, v30
s_nop 0
v_mul_f32 v44, v18, v19
v_pk_mul_f32 v[40:41], v[32:33], v[18:19] op_sel_hi:[1,0]
v_pk_mul_f32 v[42:43], v[34:35], v[18:19] op_sel_hi:[1,0]
v_fmac_f32 v44, v22, v23
v_pk_fma_f32 v[40:41], v[36:37], v[22:23], v[40:41] op_sel_hi:[1,0,1]
v_pk_fma_f32 v[42:43], v[38:39], v[22:23], v[42:43] op_sel_hi:[1,0,1]
v_fmac_f32 v44, v26, v27
v_pk_fma_f32 v[40:41], v[52:53], v[26:27], v[40:41] op_sel_hi:[1,0,1]
v_pk_fma_f32 v[42:43], v[54:55], v[26:27], v[42:43] op_sel_hi:[1,0,1]
v_fmac_f32 v44, v30, v31
v_pk_fma_f32 v[40:41], v[56:57], v[30:31], v[40:41] op_sel_hi:[1,0,1]
v_pk_fma_f32 v[42:43], v[58:59], v[30:31], v[42:43] op_sel_hi:[1,0,1]
s_nop 0
v_add_f32_dpp v44, v44, v44 row_ror:8 row_mask:0xf bank_mask:0xf
v_add_f32_dpp v40, v40, v40 row_ror:8 row_mask:0xf bank_mask:0xf
v_add_f32_dpp v41, v41, v41 row_ror:8 row_mask:0xf bank_mask:0xf
v_add_f32_dpp v42, v42, v42 row_ror:8 row_mask:0xf bank_mask:0xf
v_add_f32_dpp v43, v43, v43 row_ror:8 row_mask:0xf bank_mask:0xf
v_mov_b32 v45, v44
v_mov_b32 v46, v40
v_mov_b32 v47, v41
v_mov_b32 v48, v42
v_mov_b32 v49, v43
s_nop 1
v_permlane16_swap_b32 v44, v45
v_permlane16_swap_b32 v40, v46
v_permlane16_swap_b32 v41, v47
v_permlane16_swap_b32 v42, v48
v_permlane16_swap_b32 v43, v49
v_add_f32 v44, v44, v45
v_add_f32 v40, v40, v46
v_add_f32 v41, v41, v47
v_add_f32 v42, v42, v48
v_add_f32 v43, v43, v49
v_mov_b32 v45, v44
v_mov_b32 v46, v40
v_mov_b32 v47, v41
v_mov_b32 v48, v42
v_mov_b32 v49, v43
s_nop 1
v_permlane32_swap_b32 v44, v45
v_permlane32_swap_b32 v40, v46
v_permlane32_swap_b32 v41, v47
v_permlane32_swap_b32 v42, v48
v_permlane32_swap_b32 v43, v49
v_add_f32 v44, v44, v45
v_add_f32 v40, v40, v46
v_add_f32 v41, v41, v47
v_add_f32 v42, v42, v48
v_add_f32 v43, v43, v49
v_rcp_f32 v44, v44
s_nop 0
v_mul_f32 v40, v40, v44
v_mul_f32 v41, v41, v44
v_mul_f32 v42, v42, v44
v_mul_f32 v43, v43, v44
v_cvt_pk_bf16_f32 v40, v40, v41
v_cvt_pk_bf16_f32 v41, v42, v43
v_dot2_f32_bf16 v16, v40, v80, 0
v_dot2_f32_bf16 v17, v40, v81, 0
v_dot2_f32_bf16 v18, v40, v82, 0
v_dot2_f32_bf16 v19, v40, v83, 0
v_dot2_f32_bf16 v20, v40, v84, 0
v_dot2_f32_bf16 v21, v40, v85, 0
v_dot2_f32_bf16 v22, v40, v86, 0
v_dot2_f32_bf16 v23, v40, v87, 0
v_dot2_f32_bf16 v16, v41, v88, v16
v_dot2_f32_bf16 v17, v41, v89, v17
v_dot2_f32_bf16 v18, v41, v90, v18
v_dot2_f32_bf16 v19, v41, v91, v19
v_dot2_f32_bf16 v20, v41, v92, v20
v_dot2_f32_bf16 v21, v41, v93, v21
v_dot2_f32_bf16 v22, v41, v94, v22
v_dot2_f32_bf16 v23, v41, v95, v23
v_add_f32_dpp v16, v16, v16 quad_perm:[1,0,3,2] row_mask:0xf bank_mask:0xf
v_add_f32_dpp v17, v17, v17 quad_perm:[1,0,3,2] row_mask:0xf bank_mask:0xf
v_add_f32_dpp v18, v18, v18 quad_perm:[1,0,3,2] row_mask:0xf bank_mask:0xf
v_add_f32_dpp v19, v19, v19 quad_perm:[1,0,3,2] row_mask:0xf bank_mask:0xf
v_add_f32_dpp v20, v20, v20 quad_perm:[1,0,3,2] row_mask:0xf bank_mask:0xf
v_add_f32_dpp v21, v21, v21 quad_perm:[1,0,3,2] row_mask:0xf bank_mask:0xf
v_add_f32_dpp v22, v22, v22 quad_perm:[1,0,3,2] row_mask:0xf bank_mask:0xf
v_add_f32_dpp v23, v23, v23 quad_perm:[1,0,3,2] row_mask:0xf bank_mask:0xf
v_add_f32_dpp v16, v16, v16 quad_perm:[2,3,0,1] row_mask:0xf bank_mask:0xf
v_add_f32_dpp v17, v17, v17 quad_perm:[2,3,0,1] row_mask:0xf bank_mask:0xf
v_add_f32_dpp v18, v18, v18 quad_perm:[2,3,0,1] row_mask:0xf bank_mask:0xf
v_add_f32_dpp v19, v19, v19 quad_perm:[2,3,0,1] row_mask:0xf bank_mask:0xf
v_add_f32_dpp v20, v20, v20 quad_perm:[2,3,0,1] row_mask:0xf bank_mask:0xf
v_add_f32_dpp v21, v21, v21 quad_perm:[2,3,0,1] row_mask:0xf bank_mask:0xf
v_add_f32_dpp v22, v22, v22 quad_perm:[2,3,0,1] row_mask:0xf bank_mask:0xf
v_add_f32_dpp v23, v23, v23 quad_perm:[2,3,0,1] row_mask:0xf bank_mask:0xf
v_add_f32_dpp v16, v16, v16 row_half_mirror row_mask:0xf bank_mask:0xf
v_add_f32_dpp v17, v17, v17 row_half_mirror row_mask:0xf bank_mask:0xf
v_add_f32_dpp v18, v18, v18 row_half_mirror row_mask:0xf bank_mask:0xf
v_add_f32_dpp v19, v19, v19 row_half_mirror row_mask:0xf bank_mask:0xf
v_add_f32_dpp v20, v20, v20 row_half_mirror row_mask:0xf bank_mask:0xf
v_add_f32_dpp v21, v21, v21 row_half_mirror row_mask:0xf bank_mask:0xf
v_add_f32_dpp v22, v22, v22 row_half_mirror row_mask:0xf bank_mask:0xf
v_add_f32_dpp v23, v23, v23 row_half_mirror row_mask:0xf bank_mask:0xf
ds_write_b128 v144, v[16:19]
ds_write_b128 v144, v[20:23] offset:16
s_waitcnt lgkmcnt(0)
s_barrier
s_cmp_lg_u32 s33, 0
s_cbranch_scc1 L_hop2
L_seg_c:
ds_read_b32 v16, v145 offset:13568
ds_read_b32 v17, v145 offset:13824
ds_read_b32 v18, v145 offset:14080
ds_read_b32 v19, v145 offset:14336
s_waitcnt lgkmcnt(0)
v_add_f32 v16, v16, v17
v_add_f32 v18, v18, v19
v_add_f32 v16, v16, v18
v_min_u32 v16, 0xfffffffe, v16
buffer_store_dword v16, v145, s[44:47], s17 offen sc1
L_hop2:
s_sub_u32 s14, s33, 1
s_cmp_ge_u32 s14, 3
s_cbranch_scc1 L_hop2b
s_cmp_ge_u32 s32, 16
s_cbranch_scc1 L_hop2b
s_cmp_eq_u32 s14, 0
s_cbranch_scc1 L_red
s_sleep 3
s_cmp_eq_u32 s14, 1
s_cbranch_scc1 L_red
s_sleep 3
L_red:
s_mov_b32 s15, 200000
L_poll2a_16:
buffer_load_dwordx4 v[16:19], v146, s[44:47], s6 offen offset:0 sc1
buffer_load_dwordx4 v[20:23], v146, s[44:47], s6 offen offset:2048 sc1
buffer_load_dwordx4 v[24:27], v146, s[44:47], s7 offen offset:0 sc1
buffer_load_dwordx4 v[28:31], v146, s[44:47], s7 offen offset:2048 sc1
s_sub_u32 s15, s15, 1
s_cmp_eq_u32 s15, 0
s_cbranch_scc1 L_poll2a_16_x
s_waitcnt vmcnt(0)
v_max3_u32 v12, v16, v17, v18
v_max3_u32 v13, v19, v20, v21
v_max3_u32 v12, v12, v22, v23
v_max3_u32 v13, v13, v24, v25
v_max3_u32 v12, v12, v26, v27
v_max3_u32 v13, v13, v28, v29
v_max3_u32 v12, v12, v30, v31
v_max_u32 v12, v12, v13
v_cmp_eq_u32 vcc, -1, v12
s_and_b64 exec, exec, vcc
s_cbranch_execnz L_poll2a_16
L_poll2a_16_x:
s_mov_b64 exec, -1
s_waitcnt vmcnt(0)
L_seg_d1:
v_pk_add_f32 v[16:17], v[16:17], v[20:21]
v_pk_add_f32 v[18:19], v[18:19], v[22:23]
v_pk_add_f32 v[24:25], v[24:25], v[28:29]
v_pk_add_f32 v[26:27], v[26:27], v[30:31]
v_pk_add_f32 v[16:17], v[16:17], v[24:25]
v_pk_add_f32 v[18:19], v[18:19], v[26:27]
s_nop 0
v_add_f32_dpp v16, v16, v16 row_ror:8 row_mask:0xf bank_mask:0xf
v_add_f32_dpp v17, v17, v17 row_ror:8 row_mask:0xf bank_mask:0xf
v_add_f32_dpp v18, v18, v18 row_ror:8 row_mask:0xf bank_mask:0xf
v_add_f32_dpp v19, v19, v19 row_ror:8 row_mask:0xf bank_mask:0xf
v_mov_b32 v20, v16
v_mov_b32 v21, v17
v_mov_b32 v22, v18
v_mov_b32 v23, v19
s_nop 1
v_permlane16_swap_b32 v16, v20
v_permlane16_swap_b32 v17, v21
v_permlane16_swap_b32 v18, v22
v_permlane16_swap_b32 v19, v23
v_add_f32 v16, v16, v20
v_add_f32 v17, v17, v21
v_add_f32 v18, v18, v22
v_add_f32 v19, v19, v23
v_mov_b32 v20, v16
v_mov_b32 v21, v17
v_mov_b32 v22, v18
v_mov_b32 v23, v19
s_nop 1
v_permlane32_swap_b32 v16, v20
v_permlane32_swap_b32 v17, v21
v_permlane32_swap_b32 v18, v22
v_permlane32_swap_b32 v19, v23
v_add_f32 v16, v16, v20
v_add_f32 v17, v17, v21
v_add_f32 v18, v18, v22
v_add_f32 v19, v19, v23
v_cvt_pk_bf16_f32 v20, v16, v17
v_lshlrev_b32 v16, 16, v20
v_and_b32 v17, 0xffff0000, v20
v_cvt_pk_bf16_f32 v21, v18, v19
v_lshlrev_b32 v18, 16, v21
v_and_b32 v19, 0xffff0000, v21
v_pk_add_f32 v[16:17], v[16:17], v[128:129]
v_pk_add_f32 v[18:19], v[18:19], v[130:131]
v_cvt_pk_bf16_f32 v20, v16, v17
v_lshlrev_b32 v16, 16, v20
v_and_b32 v17, 0xffff0000, v20
v_cvt_pk_bf16_f32 v21, v18, v19
v_lshlrev_b32 v18, 16, v21
v_and_b32 v19, 0xffff0000, v21
v_readfirstlane_b32 s14, v16
s_nop 1
v_subrev_f32 v20, s14, v16
v_subrev_f32 v21, s14, v17
v_subrev_f32 v22, s14, v18
v_subrev_f32 v23, s14, v19
v_add_f32 v25, v20, v21
v_mul_f32 v26, v20, v20
v_add_f32 v24, v22, v23
v_fmac_f32 v26, v21, v21
v_add_f32 v25, v25, v24
v_fmac_f32 v26, v22, v22
v_mov_b32 v24, s14
v_fmac_f32 v26, v23, v23
v_cndmask_b32 v16, v16, v24, s[48:49]
s_nop 0
v_add_f32_dpp v25, v25, v25 quad_perm:[1,0,3,2] row_mask:0xf bank_mask:0xf
v_add_f32_dpp v26, v26, v26 quad_perm:[1,0,3,2] row_mask:0xf bank_mask:0xf
s_nop 0
v_add_f32_dpp v25, v25, v25 quad_perm:[2,3,0,1] row_mask:0xf bank_mask:0xf
v_add_f32_dpp v26, v26, v26 quad_perm:[2,3,0,1] row_mask:0xf bank_mask:0xf
s_nop 0
v_add_f32_dpp v25, v25, v25 row_half_mirror row_mask:0xf bank_mask:0xf
v_add_f32_dpp v26, v26, v26 row_half_mirror row_mask:0xf bank_mask:0xf
v_min_u32 v25, 0xfffffffe, v25
v_min_u32 v26, 0xfffffffe, v26
v_cndmask_b32 v17, v17, v25, s[48:49]
v_cndmask_b32 v18, v18, v26, s[48:49]
s_mov_b64 exec, 0x1ff
s_cmp_eq_u32 s24, 0
s_cbranch_scc1 L_st_17
buffer_store_dwordx4 v[16:19], v148, s[44:47], s25 offen
s_branch L_st_17_x
L_st_17:
buffer_store_dwordx4 v[16:19], v148, s[44:47], s25 offen sc1
L_st_17_x:
s_mov_b64 exec, -1
L_hop2b:
s_cmp_lg_u32 s33, 0
s_cbranch_scc1 L_b4
s_mov_b64 exec, 0x1ffff
s_mov_b32 s15, 200000
L_poll2b_18:
buffer_load_dwordx4 v[16:19], v147, s[44:47], s25 offen sc1
s_sub_u32 s15, s15, 1
s_cmp_eq_u32 s15, 0
s_cbranch_scc1 L_poll2b_18_x
s_waitcnt vmcnt(0)
v_max3_u32 v12, v16, v17, v18
v_max_u32 v12, v12, v19
v_cmp_eq_u32 vcc, -1, v12
s_and_b64 exec, exec, vcc
s_cbranch_execz L_poll2b_18_x
s_branch L_poll2b_18
L_poll2b_18_x:
s_mov_b64 exec, -1
s_waitcnt vmcnt(0)
L_seg_e:
v_readlane_b32 s14, v16, 0
v_readlane_b32 s72, v16, 16
v_readlane_b32 s73, v17, 16
v_readlane_b32 s74, v18, 16
v_readlane_b32 s75, v19, 16
v_subrev_f32 v20, s14, v16
v_mul_f32 v21, 0x42000000, v20
v_fma_f32 v22, 2.0, v17, v21
v_fmac_f32 v18, v20, v22
v_add_f32 v17, v17, v21
s_bitcmp1_b32 s2, 0
s_cselect_b32 s72, s74, s72
s_cselect_b32 s73, s75, s73
s_nop 0
v_add_f32_dpp v18, v18, v18 quad_perm:[1,0,3,2] row_mask:0xf bank_mask:0xf
v_add_f32_dpp v17, v17, v17 quad_perm:[1,0,3,2] row_mask:0xf bank_mask:0xf
s_nop 0
v_add_f32_dpp v18, v18, v18 quad_perm:[2,3,0,1] row_mask:0xf bank_mask:0xf
v_add_f32_dpp v17, v17, v17 quad_perm:[2,3,0,1] row_mask:0xf bank_mask:0xf
s_nop 0
v_add_f32_dpp v18, v18, v18 row_half_mirror row_mask:0xf bank_mask:0xf
v_add_f32_dpp v17, v17, v17 row_half_mirror row_mask:0xf bank_mask:0xf
s_nop 0
v_add_f32_dpp v18, v18, v18 row_mirror row_mask:0xf bank_mask:0xf
v_add_f32_dpp v17, v17, v17 row_mirror row_mask:0xf bank_mask:0xf
v_mov_b32 v24, s72
v_mov_b32 v25, s73
v_readlane_b32 s76, v17, 0
v_readlane_b32 s77, v18, 0
v_mov_b32 v48, 0x3b000000
s_nop 0
v_mul_f32 v49, s77, v48
v_mul_f32 v48, s76, v48
v_fma_f32 v49, -v48, v48, v49
v_max_f32 v49, 0, v49
v_add_f32 v48, s14, v48
v_cvt_pk_bf16_f32 v14, v48, v49
v_lshlrev_b32 v12, 16, v14
v_and_b32 v13, 0xffff0000, v14
v_add_f32 v13, 0x3727c5ac, v13
v_cvt_pk_bf16_f32 v13, v13, v13
v_lshlrev_b32 v13, 16, v13
v_sqrt_f32 v13, v13
s_nop 0
v_cvt_pk_bf16_f32 v13, v13, v13
v_lshlrev_b32 v13, 16, v13
v_rcp_f32 v13, v13
s_nop 0
v_sub_f32 v36, v24, v12
v_sub_f32 v37, v25, v12
v_cvt_pk_bf16_f32 v14, v36, v37
v_lshlrev_b32 v36, 16, v14
v_and_b32 v37, 0xffff0000, v14
v_mul_f32 v36, v36, v13
v_mul_f32 v37, v37, v13
v_cvt_pk_bf16_f32 v14, v36, v37
v_lshlrev_b32 v36, 16, v14
v_and_b32 v37, 0xffff0000, v14
v_sub_f32 v48, v48, v12
v_mul_f32 v49, v49, v13
v_mul_f32 v48, v48, v13
v_mul_f32 v49, v49, v13
v_cvt_pk_bf16_f32 v14, v48, v49
v_lshlrev_b32 v12, 16, v14
v_and_b32 v13, 0xffff0000, v14
v_add_f32 v13, 0x3727c5ac, v13
v_cvt_pk_bf16_f32 v13, v13, v13
v_lshlrev_b32 v13, 16, v13
v_sqrt_f32 v13, v13
s_nop 0
v_cvt_pk_bf16_f32 v13, v13, v13
v_lshlrev_b32 v13, 16, v13
v_rcp_f32 v13, v13
s_nop 0
v_sub_f32 v36, v36, v12
v_sub_f32 v37, v37, v12
v_cvt_pk_bf16_f32 v14, v36, v37
v_lshlrev_b32 v36, 16, v14
v_and_b32 v37, 0xffff0000, v14
v_mul_f32 v36, v36, v13
v_mul_f32 v37, v37, v13
v_cvt_pk_bf16_f32 v14, v36, v37
v_lshlrev_b32 v36, 16, v14
v_and_b32 v37, 0xffff0000, v14
ds_write_b64 v149, v[36:37]
s_waitcnt lgkmcnt(0)
L_b4:
s_setprio 0
s_barrier
L_seg_f:
ds_read_b64 v[36:37], v149
s_waitcnt lgkmcnt(0)
v_pk_mul_f32 v[40:41], v[224:225], v[36:37] op_sel:[0,0] op_sel_hi:[1,0]
v_pk_mul_f32 v[46:47], v[226:227], v[36:37] op_sel:[0,0] op_sel_hi:[1,0]
v_pk_mul_f32 v[52:53], v[224:225], v[36:37] op_sel:[0,1] op_sel_hi:[1,1]
v_pk_mul_f32 v[58:59], v[226:227], v[36:37] op_sel:[0,1] op_sel_hi:[1,1]
v_cvt_pk_bf16_f32 v42, v40, v41
v_lshlrev_b32 v40, 16, v42
v_and_b32 v41, 0xffff0000, v42
v_cvt_pk_bf16_f32 v48, v46, v47
v_lshlrev_b32 v46, 16, v48
v_and_b32 v47, 0xffff0000, v48
v_cvt_pk_bf16_f32 v54, v52, v53
v_lshlrev_b32 v52, 16, v54
v_and_b32 v53, 0xffff0000, v54
v_cvt_pk_bf16_f32 v60, v58, v59
v_lshlrev_b32 v58, 16, v60
v_and_b32 v59, 0xffff0000, v60
v_pk_add_f32 v[40:41], v[40:41], v[228:229]
v_pk_add_f32 v[46:47], v[46:47], v[230:231]
v_pk_add_f32 v[52:53], v[52:53], v[228:229]
v_pk_add_f32 v[58:59], v[58:59], v[230:231]
v_cvt_pk_bf16_f32 v42, v40, v41
v_lshlrev_b32 v40, 16, v42
v_and_b32 v41, 0xffff0000, v42
v_cvt_pk_bf16_f32 v48, v46, v47
v_lshlrev_b32 v46, 16, v48
v_and_b32 v47, 0xffff0000, v48
v_cvt_pk_bf16_f32 v54, v52, v53
v_lshlrev_b32 v52, 16, v54
v_and_b32 v53, 0xffff0000, v54
v_cvt_pk_bf16_f32 v60, v58, v59
v_lshlrev_b32 v58, 16, v60
v_and_b32 v59, 0xffff0000, v60
v_pk_mul_f32 v[42:43], v[40:41], v[40:41]
v_pk_mul_f32 v[48:49], v[46:47], v[46:47]
v_pk_mul_f32 v[54:55], v[52:53], v[52:53]
v_pk_mul_f32 v[60:61], v[58:59], v[58:59]
v_pk_fma_f32 v[42:43], v[42:43], v[240:241], v[238:239]
v_pk_fma_f32 v[48:49], v[48:49], v[240:241], v[238:239]
v_pk_fma_f32 v[54:55], v[54:55], v[240:241], v[238:239]
v_pk_fma_f32 v[60:61], v[60:61], v[240:241], v[238:239]
v_pk_mul_f32 v[44:45], v[42:43], v[40:41]
v_pk_mul_f32 v[50:51], v[48:49], v[46:47]
v_pk_mul_f32 v[56:57], v[54:55], v[52:53]
v_pk_mul_f32 v[62:63], v[60:61], v[58:59]
v_exp_f32 v44, v44
v_exp_f32 v45, v45
v_exp_f32 v50, v50
v_exp_f32 v51, v51
v_exp_f32 v56, v56
v_exp_f32 v57, v57
v_exp_f32 v62, v62
v_exp_f32 v63, v63
v_pk_add_f32 v[44:45], v[44:45], v[242:243]
v_pk_add_f32 v[50:51], v[50:51], v[242:243]
v_pk_add_f32 v[56:57], v[56:57], v[242:243]
v_pk_add_f32 v[62:63], v[62:63], v[242:243]
v_rcp_f32 v44, v44
v_rcp_f32 v45, v45
v_rcp_f32 v50, v50
v_rcp_f32 v51, v51
v_rcp_f32 v56, v56
v_rcp_f32 v57, v57
v_rcp_f32 v62, v62
v_rcp_f32 v63, v63
v_pk_mul_f32 v[40:41], v[40:41], v[44:45]
v_pk_mul_f32 v[46:47], v[46:47], v[50:51]
v_pk_mul_f32 v[52:53], v[52:53], v[56:57]
v_pk_mul_f32 v[58:59], v[58:59], v[62:63]
v_cvt_pk_bf16_f32 v40, v40, v41
v_cvt_pk_bf16_f32 v46, v46, v47
v_cvt_pk_bf16_f32 v52, v52, v53
v_cvt_pk_bf16_f32 v58, v58, v59
v_dot2_f32_bf16 v30, v40, v232, 0
v_dot2_f32_bf16 v31, v52, v232, 0
v_dot2_f32_bf16 v30, v46, v233, v30
v_dot2_f32_bf16 v31, v58, v233, v31
s_nop 1
s_nop 0
v_add_f32_dpp v30, v30, v30 quad_perm:[1,0,3,2] row_mask:0xf bank_mask:0xf
v_add_f32_dpp v31, v31, v31 quad_perm:[1,0,3,2] row_mask:0xf bank_mask:0xf
s_nop 0
v_add_f32_dpp v30, v30, v30 quad_perm:[2,3,0,1] row_mask:0xf bank_mask:0xf
v_add_f32_dpp v31, v31, v31 quad_perm:[2,3,0,1] row_mask:0xf bank_mask:0xf
s_nop 0
v_add_f32_dpp v30, v30, v30 row_half_mirror row_mask:0xf bank_mask:0xf
v_add_f32_dpp v31, v31, v31 row_half_mirror row_mask:0xf bank_mask:0xf
s_nop 0
v_add_f32_dpp v30, v30, v30 row_mirror row_mask:0xf bank_mask:0xf
v_add_f32_dpp v31, v31, v31 row_mirror row_mask:0xf bank_mask:0xf
s_nop 0
v_add_f32_dpp v30, v30, v30 row_bcast:15 row_mask:0xa bank_mask:0xf
v_add_f32_dpp v31, v31, v31 row_bcast:15 row_mask:0xa bank_mask:0xf
s_nop 0
v_add_f32_dpp v30, v30, v30 row_bcast:31 row_mask:0xc bank_mask:0xf
v_add_f32_dpp v31, v31, v31 row_bcast:31 row_mask:0xc bank_mask:0xf
s_nop 0
v_readlane_b32 s76, v30, 63
v_readlane_b32 s77, v31, 63
s_nop 1
v_mov_b32 v16, s76
v_mov_b32 v17, s77
s_lshl_b32 s14, s30, 3
s_add_u32 s14, s14, 16640
v_mov_b32 v18, s14
ds_write_b64 v18, v[16:17]
s_waitcnt lgkmcnt(0)
s_barrier
s_cmp_lg_u32 s30, 4
s_cbranch_scc1 L_hend_19
L_seg_g:
v_mov_b32 v12, 16640
ds_read_b128 v[40:43], v12 offset:0
ds_read_b128 v[44:47], v12 offset:16
ds_read_b128 v[48:51], v12 offset:32
ds_read_b128 v[52:55], v12 offset:48
s_waitcnt lgkmcnt(0)
v_pk_add_f32 v[40:41], v[40:41], v[42:43]
v_pk_add_f32 v[44:45], v[44:45], v[46:47]
v_pk_add_f32 v[48:49], v[48:49], v[50:51]
v_pk_add_f32 v[52:53], v[52:53], v[54:55]
v_pk_add_f32 v[40:41], v[40:41], v[44:45]
v_pk_add_f32 v[48:49], v[48:49], v[52:53]
v_pk_add_f32 v[16:17], v[40:41], v[48:49]
v_cvt_pk_bf16_f32 v20, v16, v17
v_lshlrev_b32 v16, 16, v20
v_and_b32 v17, 0xffff0000, v20
v_add_f32 v16, v16, v110
v_add_f32 v17, v17, v110
v_cvt_pk_bf16_f32 v20, v16, v17
v_lshlrev_b32 v16, 16, v20
v_and_b32 v17, 0xffff0000, v20
v_pk_add_f32 v[16:17], v[16:17], v[24:25]
v_cvt_pk_bf16_f32 v16, v16, v17
s_lshl_b32 s14, s2, 2
v_mov_b32 v18, 0
s_mov_b64 exec, 1
buffer_store_dword v16, v18, s[68:71], s14 offen
s_cmp_lg_u32 s2, 0
s_cbranch_scc1 L_hend_19
v_mov_b32 v20, s96
v_mov_b32 v21, s97
s_mov_b32 s14, 0x40000
buffer_store_dwordx2 v[20:21], v18, s[44:47], s14 offen sc1
L_hend_19:
L_end:
s_endpgm
.section .rodata,"a"
.p2align 6
.amdhsa_kernel sequential_preLN__gqa_block_cached__mixer_token_mlp__decode_kernel
  .amdhsa_next_free_vgpr 256
  .amdhsa_next_free_sgpr 102
  .amdhsa_accum_offset 256
  .amdhsa_group_segment_fixed_size 0
  .amdhsa_kernarg_size 104
  .amdhsa_user_sgpr_count 2
  .amdhsa_user_sgpr_kernarg_segment_ptr 1
  .amdhsa_system_sgpr_workgroup_id_x 1
  .amdhsa_float_denorm_mode_32 3
.end_amdhsa_kernel
```
